```python
import torch

def _softmax(x, axis=-1):
    return torch.softmax(x, dim=axis)
def _gelu(x):
    return torch.nn.functional.gelu(x, approximate="tanh")
def _silu(x):
    return torch.nn.functional.silu(x)
def _sigmoid(x):
    return torch.sigmoid(x)
def _layernorm(x, axis=-1, eps=1e-5):
    m = x.mean(dim=axis, keepdim=True)
    v = x.var(dim=axis, keepdim=True, unbiased=False)
    return (x - m) / torch.sqrt(v + eps)
def _scatter_add(tgt, idx, src, axis=0):
    return tgt.clone().index_add_(axis, idx, src)
def _segment_sum(src, seg, n):
    out = torch.zeros((n,) + src.shape[1:], dtype=src.dtype)
    return out.index_add_(0, seg, src)
def _pad(x, pw):
    flat = tuple(v for pair in reversed(pw) for v in pair)
    return torch.nn.functional.pad(x, flat)

kernel_name = 'concat_heads__sliding_block_cached__gqa_block_cached__decode'

def setup_inputs():

    _w = (lambda a: (lambda t: t.to(torch.bfloat16) if t.is_floating_point() else t)(torch.as_tensor(a)))
    def _A_setup():
        B, Sq, D = 2, 1, 512
        Hq, Hkv, Sk, Dh = 32, 8, 16384, 128
        assert Hq % Hkv == 0, (Hq, Hkv)
        return {
            "x": _w((lambda *s: torch.randn(*s, dtype=torch.bfloat16) * 0.8)(B, Sq, D)),
            "k_cache": _w((lambda *s: torch.randn(*s, dtype=torch.bfloat16) * 1.6)(B, Hkv, Sk, Dh)),
            "v_cache": _w((lambda *s: torch.randn(*s, dtype=torch.bfloat16) * 0.2)(B, Hkv, Sk, Dh)),
            "wq": _w((lambda *s: torch.randn(*s, dtype=torch.bfloat16) * 1.6)(D, Hq * Dh) * (D ** -0.5)),
            "wo": _w((lambda *s: torch.randn(*s, dtype=torch.bfloat16) * 0.2)(Hq * Dh, D) * ((Hq * Dh) ** -0.5)),
        }
    _A_in = _A_setup()

    def _B_setup():
        B, Sq, D = 2, 1, 512
        Hq, Hkv, Sk, Dh = 32, 8, 16384, 128
        assert Hq % Hkv == 0, (Hq, Hkv)
        return {
            "x": _w((lambda *s: torch.randn(*s, dtype=torch.bfloat16) * 0.8)(B, Sq, D)),
            "k_cache": _w((lambda *s: torch.randn(*s, dtype=torch.bfloat16) * 1.6)(B, Hkv, Sk, Dh)),
            "v_cache": _w((lambda *s: torch.randn(*s, dtype=torch.bfloat16) * 0.2)(B, Hkv, Sk, Dh)),
            "wq": _w((lambda *s: torch.randn(*s, dtype=torch.bfloat16) * 1.6)(D, Hq * Dh) * (D ** -0.5)),
            "wo": _w((lambda *s: torch.randn(*s, dtype=torch.bfloat16) * 0.2)(Hq * Dh, D) * ((Hq * Dh) ** -0.5)),
        }
    _B_in = _B_setup()

    return {
        "A_x": _A_in["x"],
        "A_k_cache": _A_in["k_cache"],
        "A_v_cache": _A_in["v_cache"],
        "A_wq": _A_in["wq"],
        "A_wo": _A_in["wo"],
        "B_x": _B_in["x"],
        "B_k_cache": _B_in["k_cache"],
        "B_v_cache": _B_in["v_cache"],
        "B_wq": _B_in["wq"],
        "B_wo": _B_in["wo"],
    }

def reference(A_x, A_k_cache, A_v_cache, A_wq, A_wo, B_x, B_k_cache, B_v_cache, B_wq, B_wo):
    def _A_ref(x, k_cache, v_cache, wq, wo):
        B, Sq, D = x.shape
        Hq, Dh = 32, 128
        Hkv, Sk = k_cache.shape[1], k_cache.shape[2]
        W = min(4096, max(256, Sk // 4))
        rep = Hq // Hkv
        q = (lambda x, *d: x.permute(*d))((x @ wq).reshape(B, Sq, Hq, Dh), 0, 2, 1, 3)
        k = (lambda x, n, axis: torch.repeat_interleave(x, n, dim=axis))(k_cache[:, :, Sk - W:, :], rep, axis=1)
        v = (lambda x, n, axis: torch.repeat_interleave(x, n, dim=axis))(v_cache[:, :, Sk - W:, :], rep, axis=1)
        scores = torch.einsum("bhqd,bhkd->bhqk", q, k) * (Dh ** -0.5)
        p = _softmax(scores, axis=-1)
        o = torch.einsum("bhqk,bhkd->bhqd", p, v)
        return (lambda x, *d: x.permute(*d))(o, 0, 2, 1, 3).reshape(B, Sq, Hq * Dh) @ wo

    def _B_ref(x, k_cache, v_cache, wq, wo):
        B, Sq, D = x.shape
        Hq, Dh = 32, 128
        Hkv = k_cache.shape[1]
        rep = Hq // Hkv
        q = (lambda x, *d: x.permute(*d))((x @ wq).reshape(B, Sq, Hq, Dh), 0, 2, 1, 3)
        k = (lambda x, n, axis: torch.repeat_interleave(x, n, dim=axis))(k_cache, rep, axis=1)
        v = (lambda x, n, axis: torch.repeat_interleave(x, n, dim=axis))(v_cache, rep, axis=1)
        scores = torch.einsum("bhqd,bhkd->bhqk", q, k) * (Dh ** -0.5)
        p = _softmax(scores, axis=-1)
        o = torch.einsum("bhqk,bhkd->bhqd", p, v)
        return (lambda x, *d: x.permute(*d))(o, 0, 2, 1, 3).reshape(B, Sq, Hq * Dh) @ wo

    a = _A_ref(A_x, A_k_cache, A_v_cache, A_wq, A_wo)
    b = _B_ref(B_x, B_k_cache, B_v_cache, B_wq, B_wo)
    return torch.concatenate([a, b], axis=-1)
```

```asm
; @launch grid=(256,1,1) block=(384,1,1) lds=22528
.amdgcn_target "amdgcn-amd-amdhsa--gfx950"
.text
.globl concat_heads__sliding_block_cached__gqa_block_cached__decode_kernel
.p2align 8
.type concat_heads__sliding_block_cached__gqa_block_cached__decode_kernel,@function
concat_heads__sliding_block_cached__gqa_block_cached__decode_kernel:
  s_cmp_ge_u32 s2, 256
  s_cbranch_scc1 L_END
  s_load_dwordx16 s[4:19], s[0:1], 0
  s_load_dwordx8 s[20:27], s[0:1], 64
  s_load_dwordx2 s[28:29], s[0:1], 96
  s_memrealtime s[76:77]
  v_lshrrev_b32 v1, 6, v0
  v_and_b32 v0, 63, v0
  v_readfirstlane_b32 s74, v1
  s_lshr_b32 s71, s2, 7
  s_bfe_u32 s72, s2, 0x30004
  s_and_b32 s73, s2, 15
  s_lshr_b32 s78, s2, 4
  s_lshr_b32 s79, s73, 3
  s_and_b32 s80, s73, 7
  s_lshl_b32 s80, s80, 1
  s_add_u32 s80, s80, s71
  s_mov_b32 s69, 0x05040100
  s_mov_b32 s70, 0x07060302
  s_cmp_eq_u32 s74, 4
  s_cbranch_scc1 L_QP
  s_cmp_eq_u32 s74, 5
  s_cbranch_scc1 L_AUX
  v_and_b32 v4, 15, v0
  v_lshrrev_b32 v5, 4, v0
  v_lshrrev_b32 v6, 2, v4
  v_and_b32 v7, 3, v4
  v_lshlrev_b32 v1, 8, v6
  v_lshl_add_u32 v1, v5, 6, v1
  v_lshl_add_u32 v1, v7, 4, v1
  v_lshlrev_b32 v2, 4, v0
  s_lshr_b32 s75, s2, 3
  s_add_u32 s75, s75, s2
  s_mov_b32 s60, 0
  s_mov_b32 s61, 4096
  s_mov_b32 s62, 8192
  s_mov_b32 s63, 12288
  s_mov_b32 s64, 16384
  s_mov_b32 s65, 20480
  s_mov_b32 s66, 24576
  s_mov_b32 s67, 28672
  s_lshl_b32 s47, s78, 22
  s_lshl_b32 s82, s74, 10
  s_lshl_b32 s81, s73, 16
  s_add_u32 s81, s81, s47
  s_add_u32 s81, s81, 3145728
  s_add_u32 s81, s81, s82
  s_add_u32 s47, s47, s82
  s_mov_b32 s34, 29696
  s_mov_b32 s35, 0x20000
  s_mov_b32 s38, 29696
  s_mov_b32 s39, 0x20000
  s_waitcnt lgkmcnt(0)
  s_add_u32 s84, s6, s81
  s_addc_u32 s85, s7, 0
  s_add_u32 s86, s8, s81
  s_addc_u32 s87, s9, 0
  s_add_u32 s88, s16, s47
  s_addc_u32 s89, s17, 0
  s_add_u32 s90, s18, s47
  s_addc_u32 s91, s19, 0
  s_barrier
  s_barrier
  s_add_u32 s83, s75, 0
  s_and_b32 s83, s83, 1
  s_lshl_b32 s83, s83, 15
  s_add_u32 s32, s84, s83
  s_addc_u32 s33, s85, 0
  s_add_u32 s36, s86, s83
  s_addc_u32 s37, s87, 0
  buffer_load_dwordx4 v[64:67], v1, s[32:35], s60 offen nt
  buffer_load_dwordx4 v[68:71], v1, s[32:35], s61 offen nt
  buffer_load_dwordx4 v[72:75], v1, s[32:35], s62 offen nt
  buffer_load_dwordx4 v[76:79], v1, s[32:35], s63 offen nt
  buffer_load_dwordx4 v[80:83], v1, s[32:35], s64 offen nt
  buffer_load_dwordx4 v[84:87], v1, s[32:35], s65 offen nt
  buffer_load_dwordx4 v[88:91], v1, s[32:35], s66 offen nt
  buffer_load_dwordx4 v[92:95], v1, s[32:35], s67 offen nt
  s_waitcnt vmcnt(4)
  buffer_load_dwordx4 v[96:99], v2, s[36:39], s60 offen nt
  buffer_load_dwordx4 v[100:103], v2, s[36:39], s61 offen nt
  buffer_load_dwordx4 v[104:107], v2, s[36:39], s62 offen nt
  buffer_load_dwordx4 v[108:111], v2, s[36:39], s63 offen nt
  s_waitcnt vmcnt(4)
  buffer_load_dwordx4 v[112:115], v2, s[36:39], s64 offen nt
  buffer_load_dwordx4 v[116:119], v2, s[36:39], s65 offen nt
  buffer_load_dwordx4 v[120:123], v2, s[36:39], s66 offen nt
  buffer_load_dwordx4 v[124:127], v2, s[36:39], s67 offen nt
  s_mov_b32 s68, 0x3e0293ee
  s_cmp_eq_u32 s79, 0
  s_cselect_b32 s48, s12, s22
  s_cselect_b32 s49, s13, s23
  s_lshl_b32 s83, s72, 19
  s_lshl_b32 s81, s80, 15
  s_add_u32 s83, s83, s81
  s_add_u32 s48, s48, s83
  s_addc_u32 s49, s49, 0
  s_mov_b32 s50, 0x8000
  s_mov_b32 s51, 0x20000
  v_lshlrev_b32 v24, 11, v5
  v_lshl_add_u32 v24, v4, 4, v24
  s_lshl_b32 s81, s74, 8
  v_add_u32 v24, s81, v24
  s_mov_b32 s52, s28
  s_mov_b32 s53, s29
  s_mov_b32 s54, 0x1000000
  s_mov_b32 s55, 0x20000
  s_lshl_b32 s81, s72, 17
  s_lshl_b32 s82, s74, 14
  s_add_u32 s81, s81, s82
  s_lshl_b32 s82, s71, 11
  s_add_u32 s81, s81, s82
  s_lshl_b32 s82, s73, 7
  s_add_u32 s81, s81, s82
  s_add_u32 s4, s81, 1048576
  s_lshl_b32 s81, s78, 13
  s_lshl_b32 s82, s74, 10
  s_add_u32 s81, s81, s82
  s_lshl_b32 s82, s73, 6
  s_add_u32 s81, s81, s82
  s_add_u32 s6, s81, 3145728
  s_lshl_b32 s11, s72, 4
  s_add_u32 s11, s11, s80
  s_lshl_b32 s81, s79, 19
  s_add_u32 s81, s81, 4194304
  s_lshl_b32 s82, s74, 16
  s_add_u32 s12, s81, s82
  s_lshl_b32 s82, s11, 6
  s_add_u32 s12, s12, s82
  s_lshl_b32 s81, s74, 2
  v_add_u32 v25, s81, v6
  v_lshl_add_u32 v25, v25, 2, v5
  v_mul_u32_u24 v25, 144, v25
  v_lshlrev_b32 v26, 5, v6
  v_add_u32 v26, s81, v26
  v_lshrrev_b32 v8, 5, v0
  v_bfe_u32 v9, v0, 2, 3
  v_and_b32 v10, 1, v0
  v_bfe_u32 v11, v0, 1, 1
  v_lshl_add_u32 v29, v8, 5, v9
  v_lshlrev_b32 v29, 13, v29
  v_lshl_add_u32 v29, v7, 4, v29
  v_lshlrev_b32 v30, 5, v8
  v_lshl_add_u32 v30, v10, 4, v30
  v_lshl_add_u32 v30, v9, 1, v30
  v_add_lshl_u32 v30, v30, v11, 2
  v_and_b32 v31, 1, v0
  v_lshlrev_b32 v31, 6, v31
  v_lshl_add_u32 v31, v5, 4, v31
  v_bfe_u32 v8, v0, 3, 2
  v_and_b32 v9, 7, v0
  v_lshrrev_b32 v10, 5, v0
  v_add_u32 v27, s81, v8
  v_mul_u32_u24 v27, 144, v27
  v_lshl_add_u32 v27, v9, 4, v27
  v_mul_u32_u24 v11, 9216, v10
  v_add_u32 v27, v27, v11
  v_lshlrev_b32 v28, 12, v8
  v_lshl_add_u32 v28, v9, 4, v28
  v_lshl_add_u32 v28, v10, 16, v28
  s_add_u32 s83, s75, 1
  s_and_b32 s83, s83, 1
  s_lshl_b32 s83, s83, 15
  s_add_u32 s32, s84, s83
  s_addc_u32 s33, s85, 0
  s_add_u32 s36, s86, s83
  s_addc_u32 s37, s87, 0
  s_waitcnt vmcnt(4)
  buffer_load_dwordx4 v[128:131], v1, s[32:35], s60 offen nt
  buffer_load_dwordx4 v[132:135], v1, s[32:35], s61 offen nt
  buffer_load_dwordx4 v[136:139], v1, s[32:35], s62 offen nt
  buffer_load_dwordx4 v[140:143], v1, s[32:35], s63 offen nt
  s_waitcnt vmcnt(4)
  buffer_load_dwordx4 v[144:147], v1, s[32:35], s64 offen nt
  buffer_load_dwordx4 v[148:151], v1, s[32:35], s65 offen nt
  buffer_load_dwordx4 v[152:155], v1, s[32:35], s66 offen nt
  buffer_load_dwordx4 v[156:159], v1, s[32:35], s67 offen nt
  s_waitcnt vmcnt(4)
  buffer_load_dwordx4 v[160:163], v2, s[36:39], s60 offen nt
  buffer_load_dwordx4 v[164:167], v2, s[36:39], s61 offen nt
  buffer_load_dwordx4 v[168:171], v2, s[36:39], s62 offen nt
  buffer_load_dwordx4 v[172:175], v2, s[36:39], s63 offen nt
  s_waitcnt vmcnt(4)
  buffer_load_dwordx4 v[176:179], v2, s[36:39], s64 offen nt
  buffer_load_dwordx4 v[180:183], v2, s[36:39], s65 offen nt
  buffer_load_dwordx4 v[184:187], v2, s[36:39], s66 offen nt
  buffer_load_dwordx4 v[188:191], v2, s[36:39], s67 offen nt
  v_and_b32 v6, 16, v0
  v_cmp_ne_u32 s[84:85], 0, v6
  v_and_b32 v6, 32, v0
  v_cmp_ne_u32 s[86:87], 0, v6
  v_mov_b32 v3, 0xff7fffff
  v_mov_b32 v4, 0
  v_mov_b32 v32, 0
  v_mov_b32 v33, 0
  v_mov_b32 v34, 0
  v_mov_b32 v35, 0
  v_mov_b32 v36, 0
  v_mov_b32 v37, 0
  v_mov_b32 v38, 0
  v_mov_b32 v39, 0
  v_mov_b32 v40, 0
  v_mov_b32 v41, 0
  v_mov_b32 v42, 0
  v_mov_b32 v43, 0
  v_mov_b32 v44, 0
  v_mov_b32 v45, 0
  v_mov_b32 v46, 0
  v_mov_b32 v47, 0
  v_mov_b32 v48, 0
  v_mov_b32 v49, 0
  v_mov_b32 v50, 0
  v_mov_b32 v51, 0
  v_mov_b32 v52, 0
  v_mov_b32 v53, 0
  v_mov_b32 v54, 0
  v_mov_b32 v55, 0
  v_mov_b32 v56, 0
  v_mov_b32 v57, 0
  v_mov_b32 v58, 0
  v_mov_b32 v59, 0
  v_mov_b32 v60, 0
  v_mov_b32 v61, 0
  v_mov_b32 v62, 0
  v_mov_b32 v63, 0
  s_mov_b32 s43, 0
  s_mov_b32 s44, 0
  s_mov_b32 s45, 0
  s_lshl_b32 s40, s73, 18
  s_mov_b32 s41, s40
  s_mov_b32 s42, 7
  s_mov_b32 s46, 15
  s_barrier
  ds_read_b128 v[8:11], v2 offset:0
  v_mov_b32 v6, 2048
  ds_read_b64 v[12:13], v6
  s_mov_b32 s34, 54272
  s_mov_b32 s38, 54272
  s_waitcnt lgkmcnt(0)
  v_readfirstlane_b32 s76, v12
  v_readfirstlane_b32 s77, v13
L_LOOP:
L_B0:
  s_waitcnt vmcnt(24)
  s_cmp_eq_u32 s45, 1
  s_cbranch_scc0 L_TW0
  s_waitcnt vmcnt(8)
L_TW0:
  v_mfma_f32_16x16x32_bf16 v[64:67], v[64:67], v[8:11], 0
  v_mfma_f32_16x16x32_bf16 v[68:71], v[68:71], v[8:11], 0
  v_mfma_f32_16x16x32_bf16 v[72:75], v[72:75], v[8:11], 0
  v_mfma_f32_16x16x32_bf16 v[76:79], v[76:79], v[8:11], 0
  v_mfma_f32_16x16x32_bf16 v[80:83], v[80:83], v[8:11], 0
  v_mfma_f32_16x16x32_bf16 v[84:87], v[84:87], v[8:11], 0
  v_mfma_f32_16x16x32_bf16 v[88:91], v[88:91], v[8:11], 0
  v_mfma_f32_16x16x32_bf16 v[92:95], v[92:95], v[8:11], 0
  s_nop 0
  v_mov_b32_dpp v64, v64 quad_perm:[0,0,0,0] row_mask:0xf bank_mask:0xf
  v_mov_b32_dpp v68, v68 quad_perm:[0,0,0,0] row_mask:0xf bank_mask:0xf
  v_mov_b32_dpp v72, v72 quad_perm:[0,0,0,0] row_mask:0xf bank_mask:0xf
  v_mov_b32_dpp v76, v76 quad_perm:[0,0,0,0] row_mask:0xf bank_mask:0xf
  v_mov_b32_dpp v80, v80 quad_perm:[0,0,0,0] row_mask:0xf bank_mask:0xf
  v_mov_b32_dpp v84, v84 quad_perm:[0,0,0,0] row_mask:0xf bank_mask:0xf
  v_mov_b32_dpp v88, v88 quad_perm:[0,0,0,0] row_mask:0xf bank_mask:0xf
  v_mov_b32_dpp v92, v92 quad_perm:[0,0,0,0] row_mask:0xf bank_mask:0xf
  v_add_f32_dpp v64, v65, v64 quad_perm:[1,1,1,1] row_mask:0xf bank_mask:0xf
  v_add_f32_dpp v68, v69, v68 quad_perm:[1,1,1,1] row_mask:0xf bank_mask:0xf
  v_add_f32_dpp v72, v73, v72 quad_perm:[1,1,1,1] row_mask:0xf bank_mask:0xf
  v_add_f32_dpp v76, v77, v76 quad_perm:[1,1,1,1] row_mask:0xf bank_mask:0xf
  v_add_f32_dpp v80, v81, v80 quad_perm:[1,1,1,1] row_mask:0xf bank_mask:0xf
  v_add_f32_dpp v84, v85, v84 quad_perm:[1,1,1,1] row_mask:0xf bank_mask:0xf
  v_add_f32_dpp v88, v89, v88 quad_perm:[1,1,1,1] row_mask:0xf bank_mask:0xf
  v_add_f32_dpp v92, v93, v92 quad_perm:[1,1,1,1] row_mask:0xf bank_mask:0xf
  v_add_f32_dpp v64, v66, v64 quad_perm:[2,2,2,2] row_mask:0xf bank_mask:0xf
  v_add_f32_dpp v68, v70, v68 quad_perm:[2,2,2,2] row_mask:0xf bank_mask:0xf
  v_add_f32_dpp v72, v74, v72 quad_perm:[2,2,2,2] row_mask:0xf bank_mask:0xf
  v_add_f32_dpp v76, v78, v76 quad_perm:[2,2,2,2] row_mask:0xf bank_mask:0xf
  v_add_f32_dpp v80, v82, v80 quad_perm:[2,2,2,2] row_mask:0xf bank_mask:0xf
  v_add_f32_dpp v84, v86, v84 quad_perm:[2,2,2,2] row_mask:0xf bank_mask:0xf
  v_add_f32_dpp v88, v90, v88 quad_perm:[2,2,2,2] row_mask:0xf bank_mask:0xf
  v_add_f32_dpp v92, v94, v92 quad_perm:[2,2,2,2] row_mask:0xf bank_mask:0xf
  v_add_f32_dpp v64, v67, v64 quad_perm:[3,3,3,3] row_mask:0xf bank_mask:0xf
  v_add_f32_dpp v68, v71, v68 quad_perm:[3,3,3,3] row_mask:0xf bank_mask:0xf
  v_add_f32_dpp v72, v75, v72 quad_perm:[3,3,3,3] row_mask:0xf bank_mask:0xf
  v_add_f32_dpp v76, v79, v76 quad_perm:[3,3,3,3] row_mask:0xf bank_mask:0xf
  v_add_f32_dpp v80, v83, v80 quad_perm:[3,3,3,3] row_mask:0xf bank_mask:0xf
  v_add_f32_dpp v84, v87, v84 quad_perm:[3,3,3,3] row_mask:0xf bank_mask:0xf
  v_add_f32_dpp v88, v91, v88 quad_perm:[3,3,3,3] row_mask:0xf bank_mask:0xf
  v_add_f32_dpp v92, v95, v92 quad_perm:[3,3,3,3] row_mask:0xf bank_mask:0xf
  v_max3_f32 v6, v64, v68, v72
  v_max3_f32 v7, v76, v80, v84
  v_max3_f32 v6, v6, v88, v92
  v_max_f32 v6, v6, v7
  v_mov_b32 v7, v6
  s_nop 1
  v_permlane16_swap_b32 v6, v7
  v_max_f32 v6, v6, v7
  v_mov_b32 v7, v6
  s_nop 1
  v_permlane32_swap_b32 v6, v7
  v_max_f32 v6, v6, v7
  v_mul_f32 v6, s68, v6
  v_max_f32 v6, v3, v6
  v_sub_f32 v5, v3, v6
  v_mov_b32 v3, v6
  v_exp_f32 v5, v5
  v_fma_f32 v64, v64, s68, -v3
  v_fma_f32 v68, v68, s68, -v3
  v_fma_f32 v72, v72, s68, -v3
  v_fma_f32 v76, v76, s68, -v3
  v_fma_f32 v80, v80, s68, -v3
  v_fma_f32 v84, v84, s68, -v3
  v_fma_f32 v88, v88, s68, -v3
  v_fma_f32 v92, v92, s68, -v3
  v_exp_f32 v64, v64
  v_exp_f32 v68, v68
  v_exp_f32 v72, v72
  v_exp_f32 v76, v76
  v_exp_f32 v80, v80
  v_exp_f32 v84, v84
  v_exp_f32 v88, v88
  v_exp_f32 v92, v92
  v_mul_f32 v32, v5, v32
  v_mul_f32 v33, v5, v33
  v_mul_f32 v34, v5, v34
  v_mul_f32 v35, v5, v35
  v_mul_f32 v36, v5, v36
  v_mul_f32 v37, v5, v37
  v_mul_f32 v38, v5, v38
  v_mul_f32 v39, v5, v39
  v_mul_f32 v40, v5, v40
  v_mul_f32 v41, v5, v41
  v_mul_f32 v42, v5, v42
  v_mul_f32 v43, v5, v43
  v_mul_f32 v44, v5, v44
  v_mul_f32 v45, v5, v45
  v_mul_f32 v46, v5, v46
  v_mul_f32 v47, v5, v47
  v_mul_f32 v48, v5, v48
  v_mul_f32 v49, v5, v49
  v_mul_f32 v50, v5, v50
  v_mul_f32 v51, v5, v51
  v_mul_f32 v52, v5, v52
  v_mul_f32 v53, v5, v53
  v_mul_f32 v54, v5, v54
  v_mul_f32 v55, v5, v55
  v_mul_f32 v56, v5, v56
  v_mul_f32 v57, v5, v57
  v_mul_f32 v58, v5, v58
  v_mul_f32 v59, v5, v59
  v_mul_f32 v60, v5, v60
  v_mul_f32 v61, v5, v61
  v_mul_f32 v62, v5, v62
  v_mul_f32 v63, v5, v63
  v_cvt_pk_bf16_f32 v12, v64, v68
  v_cvt_pk_bf16_f32 v13, v72, v76
  v_cvt_pk_bf16_f32 v14, v80, v84
  v_cvt_pk_bf16_f32 v15, v88, v92
  v_add_f32 v6, v64, v68
  v_add_f32 v7, v72, v76
  v_add_f32 v80, v80, v84
  v_add_f32 v88, v88, v92
  v_add_f32 v6, v6, v7
  v_add_f32 v80, v80, v88
  v_add_f32 v6, v6, v80
  v_fma_f32 v4, v4, v5, v6
  s_cmp_eq_u32 s45, 0
  s_cbranch_scc0 L_NK0
  s_cmp_lt_u32 s43, 8
  s_cbranch_scc1 L_GO0
  s_mov_b32 s45, 2
  s_branch L_NK0
L_GO0:
  s_add_u32 s81, s75, s43
  s_and_b32 s83, s81, s42
  s_lshl_b32 s83, s83, s46
  s_bitcmp1_b32 s81, 2
  s_cselect_b32 s81, s41, s40
  s_add_u32 s83, s83, s81
  s_add_u32 s32, s88, s83
  s_addc_u32 s33, s89, 0
  s_add_u32 s36, s90, s83
  s_addc_u32 s37, s91, 0
  s_add_u32 s43, s43, 1
  s_waitcnt vmcnt(4)
  buffer_load_dwordx4 v[64:67], v1, s[32:35], s60 offen nt
  buffer_load_dwordx4 v[68:71], v1, s[32:35], s61 offen nt
  buffer_load_dwordx4 v[72:75], v1, s[32:35], s62 offen nt
  buffer_load_dwordx4 v[76:79], v1, s[32:35], s63 offen nt
  s_waitcnt vmcnt(4)
  buffer_load_dwordx4 v[80:83], v1, s[32:35], s64 offen nt
  buffer_load_dwordx4 v[84:87], v1, s[32:35], s65 offen nt
  buffer_load_dwordx4 v[88:91], v1, s[32:35], s66 offen nt
  buffer_load_dwordx4 v[92:95], v1, s[32:35], s67 offen nt
L_NK0:
  s_waitcnt vmcnt(24)
  s_cmp_eq_u32 s45, 1
  s_cbranch_scc0 L_V10
  s_waitcnt vmcnt(0)
  s_mov_b32 s83, 0
  buffer_load_dwordx4 v[192:195], v24, s[48:51], s83 offen offset:0 nt
  s_mov_b32 s83, 8192
  buffer_load_dwordx4 v[196:199], v24, s[48:51], s83 offen offset:0 nt
  s_mov_b32 s83, 16384
  buffer_load_dwordx4 v[200:203], v24, s[48:51], s83 offen offset:0 nt
  s_mov_b32 s83, 24576
  buffer_load_dwordx4 v[204:207], v24, s[48:51], s83 offen offset:0 nt
  s_mov_b32 s83, 0
  buffer_load_dwordx4 v[208:211], v24, s[48:51], s83 offen offset:1024 nt
  s_mov_b32 s83, 8192
  buffer_load_dwordx4 v[212:215], v24, s[48:51], s83 offen offset:1024 nt
  s_mov_b32 s83, 16384
  buffer_load_dwordx4 v[216:219], v24, s[48:51], s83 offen offset:1024 nt
  s_mov_b32 s83, 24576
  buffer_load_dwordx4 v[220:223], v24, s[48:51], s83 offen offset:1024 nt
L_V10:
  s_cmp_eq_u32 s45, 2
  s_cbranch_scc0 L_V20
  s_waitcnt vmcnt(16)
L_V20:
  v_perm_b32 v16, v100, v96, s69
  v_perm_b32 v17, v108, v104, s69
  v_perm_b32 v18, v116, v112, s69
  v_perm_b32 v19, v124, v120, s69
  v_perm_b32 v20, v100, v96, s70
  v_perm_b32 v21, v108, v104, s70
  v_perm_b32 v22, v116, v112, s70
  v_perm_b32 v23, v124, v120, s70
  v_mfma_f32_16x16x32_bf16 v[32:35], v[16:19], v[12:15], v[32:35]
  v_perm_b32 v16, v101, v97, s69
  v_perm_b32 v17, v109, v105, s69
  v_perm_b32 v18, v117, v113, s69
  v_perm_b32 v19, v125, v121, s69
  v_mfma_f32_16x16x32_bf16 v[36:39], v[20:23], v[12:15], v[36:39]
  v_perm_b32 v20, v101, v97, s70
  v_perm_b32 v21, v109, v105, s70
  v_perm_b32 v22, v117, v113, s70
  v_perm_b32 v23, v125, v121, s70
  v_mfma_f32_16x16x32_bf16 v[40:43], v[16:19], v[12:15], v[40:43]
  v_perm_b32 v16, v102, v98, s69
  v_perm_b32 v17, v110, v106, s69
  v_perm_b32 v18, v118, v114, s69
  v_perm_b32 v19, v126, v122, s69
  v_mfma_f32_16x16x32_bf16 v[44:47], v[20:23], v[12:15], v[44:47]
  v_perm_b32 v20, v102, v98, s70
  v_perm_b32 v21, v110, v106, s70
  v_perm_b32 v22, v118, v114, s70
  v_perm_b32 v23, v126, v122, s70
  v_mfma_f32_16x16x32_bf16 v[48:51], v[16:19], v[12:15], v[48:51]
  v_perm_b32 v16, v103, v99, s69
  v_perm_b32 v17, v111, v107, s69
  v_perm_b32 v18, v119, v115, s69
  v_perm_b32 v19, v127, v123, s69
  v_mfma_f32_16x16x32_bf16 v[52:55], v[20:23], v[12:15], v[52:55]
  v_perm_b32 v20, v103, v99, s70
  v_perm_b32 v21, v111, v107, s70
  v_perm_b32 v22, v119, v115, s70
  v_perm_b32 v23, v127, v123, s70
  v_mfma_f32_16x16x32_bf16 v[56:59], v[16:19], v[12:15], v[56:59]
  s_nop 0
  v_mfma_f32_16x16x32_bf16 v[60:63], v[20:23], v[12:15], v[60:63]
  s_cmp_eq_u32 s45, 0
  s_cbranch_scc0 L_NV0
  s_waitcnt vmcnt(4)
  buffer_load_dwordx4 v[96:99], v2, s[36:39], s60 offen nt
  buffer_load_dwordx4 v[100:103], v2, s[36:39], s61 offen nt
  buffer_load_dwordx4 v[104:107], v2, s[36:39], s62 offen nt
  buffer_load_dwordx4 v[108:111], v2, s[36:39], s63 offen nt
  s_waitcnt vmcnt(4)
  buffer_load_dwordx4 v[112:115], v2, s[36:39], s64 offen nt
  buffer_load_dwordx4 v[116:119], v2, s[36:39], s65 offen nt
  buffer_load_dwordx4 v[120:123], v2, s[36:39], s66 offen nt
  buffer_load_dwordx4 v[124:127], v2, s[36:39], s67 offen nt
L_NV0:
  s_add_u32 s44, s44, 1
  s_cmp_eq_u32 s45, 0
  s_cbranch_scc1 L_B1
  s_sub_u32 s45, s45, 1
  s_cmp_eq_u32 s45, 0
  s_cbranch_scc1 L_DONE
L_B1:
  s_waitcnt vmcnt(24)
  s_cmp_eq_u32 s45, 1
  s_cbranch_scc0 L_TW1
  s_waitcnt vmcnt(8)
L_TW1:
  v_mfma_f32_16x16x32_bf16 v[128:131], v[128:131], v[8:11], 0
  v_mfma_f32_16x16x32_bf16 v[132:135], v[132:135], v[8:11], 0
  v_mfma_f32_16x16x32_bf16 v[136:139], v[136:139], v[8:11], 0
  v_mfma_f32_16x16x32_bf16 v[140:143], v[140:143], v[8:11], 0
  v_mfma_f32_16x16x32_bf16 v[144:147], v[144:147], v[8:11], 0
  v_mfma_f32_16x16x32_bf16 v[148:151], v[148:151], v[8:11], 0
  v_mfma_f32_16x16x32_bf16 v[152:155], v[152:155], v[8:11], 0
  v_mfma_f32_16x16x32_bf16 v[156:159], v[156:159], v[8:11], 0
  s_nop 0
  v_mov_b32_dpp v128, v128 quad_perm:[0,0,0,0] row_mask:0xf bank_mask:0xf
  v_mov_b32_dpp v132, v132 quad_perm:[0,0,0,0] row_mask:0xf bank_mask:0xf
  v_mov_b32_dpp v136, v136 quad_perm:[0,0,0,0] row_mask:0xf bank_mask:0xf
  v_mov_b32_dpp v140, v140 quad_perm:[0,0,0,0] row_mask:0xf bank_mask:0xf
  v_mov_b32_dpp v144, v144 quad_perm:[0,0,0,0] row_mask:0xf bank_mask:0xf
  v_mov_b32_dpp v148, v148 quad_perm:[0,0,0,0] row_mask:0xf bank_mask:0xf
  v_mov_b32_dpp v152, v152 quad_perm:[0,0,0,0] row_mask:0xf bank_mask:0xf
  v_mov_b32_dpp v156, v156 quad_perm:[0,0,0,0] row_mask:0xf bank_mask:0xf
  v_add_f32_dpp v128, v129, v128 quad_perm:[1,1,1,1] row_mask:0xf bank_mask:0xf
  v_add_f32_dpp v132, v133, v132 quad_perm:[1,1,1,1] row_mask:0xf bank_mask:0xf
  v_add_f32_dpp v136, v137, v136 quad_perm:[1,1,1,1] row_mask:0xf bank_mask:0xf
  v_add_f32_dpp v140, v141, v140 quad_perm:[1,1,1,1] row_mask:0xf bank_mask:0xf
  v_add_f32_dpp v144, v145, v144 quad_perm:[1,1,1,1] row_mask:0xf bank_mask:0xf
  v_add_f32_dpp v148, v149, v148 quad_perm:[1,1,1,1] row_mask:0xf bank_mask:0xf
  v_add_f32_dpp v152, v153, v152 quad_perm:[1,1,1,1] row_mask:0xf bank_mask:0xf
  v_add_f32_dpp v156, v157, v156 quad_perm:[1,1,1,1] row_mask:0xf bank_mask:0xf
  v_add_f32_dpp v128, v130, v128 quad_perm:[2,2,2,2] row_mask:0xf bank_mask:0xf
  v_add_f32_dpp v132, v134, v132 quad_perm:[2,2,2,2] row_mask:0xf bank_mask:0xf
  v_add_f32_dpp v136, v138, v136 quad_perm:[2,2,2,2] row_mask:0xf bank_mask:0xf
  v_add_f32_dpp v140, v142, v140 quad_perm:[2,2,2,2] row_mask:0xf bank_mask:0xf
  v_add_f32_dpp v144, v146, v144 quad_perm:[2,2,2,2] row_mask:0xf bank_mask:0xf
  v_add_f32_dpp v148, v150, v148 quad_perm:[2,2,2,2] row_mask:0xf bank_mask:0xf
  v_add_f32_dpp v152, v154, v152 quad_perm:[2,2,2,2] row_mask:0xf bank_mask:0xf
  v_add_f32_dpp v156, v158, v156 quad_perm:[2,2,2,2] row_mask:0xf bank_mask:0xf
  v_add_f32_dpp v128, v131, v128 quad_perm:[3,3,3,3] row_mask:0xf bank_mask:0xf
  v_add_f32_dpp v132, v135, v132 quad_perm:[3,3,3,3] row_mask:0xf bank_mask:0xf
  v_add_f32_dpp v136, v139, v136 quad_perm:[3,3,3,3] row_mask:0xf bank_mask:0xf
  v_add_f32_dpp v140, v143, v140 quad_perm:[3,3,3,3] row_mask:0xf bank_mask:0xf
  v_add_f32_dpp v144, v147, v144 quad_perm:[3,3,3,3] row_mask:0xf bank_mask:0xf
  v_add_f32_dpp v148, v151, v148 quad_perm:[3,3,3,3] row_mask:0xf bank_mask:0xf
  v_add_f32_dpp v152, v155, v152 quad_perm:[3,3,3,3] row_mask:0xf bank_mask:0xf
  v_add_f32_dpp v156, v159, v156 quad_perm:[3,3,3,3] row_mask:0xf bank_mask:0xf
  v_max3_f32 v6, v128, v132, v136
  v_max3_f32 v7, v140, v144, v148
  v_max3_f32 v6, v6, v152, v156
  v_max_f32 v6, v6, v7
  v_mov_b32 v7, v6
  s_nop 1
  v_permlane16_swap_b32 v6, v7
  v_max_f32 v6, v6, v7
  v_mov_b32 v7, v6
  s_nop 1
  v_permlane32_swap_b32 v6, v7
  v_max_f32 v6, v6, v7
  v_mul_f32 v6, s68, v6
  v_max_f32 v6, v3, v6
  v_sub_f32 v5, v3, v6
  v_mov_b32 v3, v6
  v_exp_f32 v5, v5
  v_fma_f32 v128, v128, s68, -v3
  v_fma_f32 v132, v132, s68, -v3
  v_fma_f32 v136, v136, s68, -v3
  v_fma_f32 v140, v140, s68, -v3
  v_fma_f32 v144, v144, s68, -v3
  v_fma_f32 v148, v148, s68, -v3
  v_fma_f32 v152, v152, s68, -v3
  v_fma_f32 v156, v156, s68, -v3
  v_exp_f32 v128, v128
  v_exp_f32 v132, v132
  v_exp_f32 v136, v136
  v_exp_f32 v140, v140
  v_exp_f32 v144, v144
  v_exp_f32 v148, v148
  v_exp_f32 v152, v152
  v_exp_f32 v156, v156
  v_mul_f32 v32, v5, v32
  v_mul_f32 v33, v5, v33
  v_mul_f32 v34, v5, v34
  v_mul_f32 v35, v5, v35
  v_mul_f32 v36, v5, v36
  v_mul_f32 v37, v5, v37
  v_mul_f32 v38, v5, v38
  v_mul_f32 v39, v5, v39
  v_mul_f32 v40, v5, v40
  v_mul_f32 v41, v5, v41
  v_mul_f32 v42, v5, v42
  v_mul_f32 v43, v5, v43
  v_mul_f32 v44, v5, v44
  v_mul_f32 v45, v5, v45
  v_mul_f32 v46, v5, v46
  v_mul_f32 v47, v5, v47
  v_mul_f32 v48, v5, v48
  v_mul_f32 v49, v5, v49
  v_mul_f32 v50, v5, v50
  v_mul_f32 v51, v5, v51
  v_mul_f32 v52, v5, v52
  v_mul_f32 v53, v5, v53
  v_mul_f32 v54, v5, v54
  v_mul_f32 v55, v5, v55
  v_mul_f32 v56, v5, v56
  v_mul_f32 v57, v5, v57
  v_mul_f32 v58, v5, v58
  v_mul_f32 v59, v5, v59
  v_mul_f32 v60, v5, v60
  v_mul_f32 v61, v5, v61
  v_mul_f32 v62, v5, v62
  v_mul_f32 v63, v5, v63
  v_cvt_pk_bf16_f32 v12, v128, v132
  v_cvt_pk_bf16_f32 v13, v136, v140
  v_cvt_pk_bf16_f32 v14, v144, v148
  v_cvt_pk_bf16_f32 v15, v152, v156
  v_add_f32 v6, v128, v132
  v_add_f32 v7, v136, v140
  v_add_f32 v144, v144, v148
  v_add_f32 v152, v152, v156
  v_add_f32 v6, v6, v7
  v_add_f32 v144, v144, v152
  v_add_f32 v6, v6, v144
  v_fma_f32 v4, v4, v5, v6
  s_cmp_eq_u32 s45, 0
  s_cbranch_scc0 L_NK1
  s_cmp_lt_u32 s43, 8
  s_cbranch_scc1 L_GO1
  s_mov_b32 s45, 2
  s_branch L_NK1
L_GO1:
  s_add_u32 s81, s75, s43
  s_and_b32 s83, s81, s42
  s_lshl_b32 s83, s83, s46
  s_bitcmp1_b32 s81, 2
  s_cselect_b32 s81, s41, s40
  s_add_u32 s83, s83, s81
  s_add_u32 s32, s88, s83
  s_addc_u32 s33, s89, 0
  s_add_u32 s36, s90, s83
  s_addc_u32 s37, s91, 0
  s_add_u32 s43, s43, 1
  s_waitcnt vmcnt(4)
  buffer_load_dwordx4 v[128:131], v1, s[32:35], s60 offen nt
  buffer_load_dwordx4 v[132:135], v1, s[32:35], s61 offen nt
  buffer_load_dwordx4 v[136:139], v1, s[32:35], s62 offen nt
  buffer_load_dwordx4 v[140:143], v1, s[32:35], s63 offen nt
  s_waitcnt vmcnt(4)
  buffer_load_dwordx4 v[144:147], v1, s[32:35], s64 offen nt
  buffer_load_dwordx4 v[148:151], v1, s[32:35], s65 offen nt
  buffer_load_dwordx4 v[152:155], v1, s[32:35], s66 offen nt
  buffer_load_dwordx4 v[156:159], v1, s[32:35], s67 offen nt
L_NK1:
  s_waitcnt vmcnt(24)
  s_cmp_eq_u32 s45, 1
  s_cbranch_scc0 L_V11
  s_waitcnt vmcnt(0)
  s_mov_b32 s83, 0
  buffer_load_dwordx4 v[192:195], v24, s[48:51], s83 offen offset:0 nt
  s_mov_b32 s83, 8192
  buffer_load_dwordx4 v[196:199], v24, s[48:51], s83 offen offset:0 nt
  s_mov_b32 s83, 16384
  buffer_load_dwordx4 v[200:203], v24, s[48:51], s83 offen offset:0 nt
  s_mov_b32 s83, 24576
  buffer_load_dwordx4 v[204:207], v24, s[48:51], s83 offen offset:0 nt
  s_mov_b32 s83, 0
  buffer_load_dwordx4 v[208:211], v24, s[48:51], s83 offen offset:1024 nt
  s_mov_b32 s83, 8192
  buffer_load_dwordx4 v[212:215], v24, s[48:51], s83 offen offset:1024 nt
  s_mov_b32 s83, 16384
  buffer_load_dwordx4 v[216:219], v24, s[48:51], s83 offen offset:1024 nt
  s_mov_b32 s83, 24576
  buffer_load_dwordx4 v[220:223], v24, s[48:51], s83 offen offset:1024 nt
L_V11:
  s_cmp_eq_u32 s45, 2
  s_cbranch_scc0 L_V21
  s_waitcnt vmcnt(16)
L_V21:
  v_perm_b32 v16, v164, v160, s69
  v_perm_b32 v17, v172, v168, s69
  v_perm_b32 v18, v180, v176, s69
  v_perm_b32 v19, v188, v184, s69
  v_perm_b32 v20, v164, v160, s70
  v_perm_b32 v21, v172, v168, s70
  v_perm_b32 v22, v180, v176, s70
  v_perm_b32 v23, v188, v184, s70
  v_mfma_f32_16x16x32_bf16 v[32:35], v[16:19], v[12:15], v[32:35]
  v_perm_b32 v16, v165, v161, s69
  v_perm_b32 v17, v173, v169, s69
  v_perm_b32 v18, v181, v177, s69
  v_perm_b32 v19, v189, v185, s69
  v_mfma_f32_16x16x32_bf16 v[36:39], v[20:23], v[12:15], v[36:39]
  v_perm_b32 v20, v165, v161, s70
  v_perm_b32 v21, v173, v169, s70
  v_perm_b32 v22, v181, v177, s70
  v_perm_b32 v23, v189, v185, s70
  v_mfma_f32_16x16x32_bf16 v[40:43], v[16:19], v[12:15], v[40:43]
  v_perm_b32 v16, v166, v162, s69
  v_perm_b32 v17, v174, v170, s69
  v_perm_b32 v18, v182, v178, s69
  v_perm_b32 v19, v190, v186, s69
  v_mfma_f32_16x16x32_bf16 v[44:47], v[20:23], v[12:15], v[44:47]
  v_perm_b32 v20, v166, v162, s70
  v_perm_b32 v21, v174, v170, s70
  v_perm_b32 v22, v182, v178, s70
  v_perm_b32 v23, v190, v186, s70
  v_mfma_f32_16x16x32_bf16 v[48:51], v[16:19], v[12:15], v[48:51]
  v_perm_b32 v16, v167, v163, s69
  v_perm_b32 v17, v175, v171, s69
  v_perm_b32 v18, v183, v179, s69
  v_perm_b32 v19, v191, v187, s69
  v_mfma_f32_16x16x32_bf16 v[52:55], v[20:23], v[12:15], v[52:55]
  v_perm_b32 v20, v167, v163, s70
  v_perm_b32 v21, v175, v171, s70
  v_perm_b32 v22, v183, v179, s70
  v_perm_b32 v23, v191, v187, s70
  v_mfma_f32_16x16x32_bf16 v[56:59], v[16:19], v[12:15], v[56:59]
  s_nop 0
  v_mfma_f32_16x16x32_bf16 v[60:63], v[20:23], v[12:15], v[60:63]
  s_cmp_eq_u32 s45, 0
  s_cbranch_scc0 L_NV1
  s_waitcnt vmcnt(4)
  buffer_load_dwordx4 v[160:163], v2, s[36:39], s60 offen nt
  buffer_load_dwordx4 v[164:167], v2, s[36:39], s61 offen nt
  buffer_load_dwordx4 v[168:171], v2, s[36:39], s62 offen nt
  buffer_load_dwordx4 v[172:175], v2, s[36:39], s63 offen nt
  s_waitcnt vmcnt(4)
  buffer_load_dwordx4 v[176:179], v2, s[36:39], s64 offen nt
  buffer_load_dwordx4 v[180:183], v2, s[36:39], s65 offen nt
  buffer_load_dwordx4 v[184:187], v2, s[36:39], s66 offen nt
  buffer_load_dwordx4 v[188:191], v2, s[36:39], s67 offen nt
L_NV1:
  s_add_u32 s44, s44, 1
  s_cmp_eq_u32 s44, 2
  s_cbranch_scc0 L_NF1
  v_mov_b32 v7, v4
  s_nop 1
  v_permlane16_swap_b32 v4, v7
  v_add_f32 v4, v4, v7
  v_mov_b32 v7, v4
  s_nop 1
  v_permlane32_swap_b32 v4, v7
  v_add_f32 v4, v4, v7
  s_mov_b32 exec_lo, 0x11111111
  s_mov_b32 exec_hi, 0x11111111
  ds_write_b128 v25, v[32:35] offset:4096
  ds_write_b128 v25, v[36:39] offset:4112
  ds_write_b128 v25, v[40:43] offset:4128
  ds_write_b128 v25, v[44:47] offset:4144
  ds_write_b128 v25, v[48:51] offset:4160
  ds_write_b128 v25, v[52:55] offset:4176
  ds_write_b128 v25, v[56:59] offset:4192
  ds_write_b128 v25, v[60:63] offset:4208
  s_mov_b32 exec_lo, 0x1111
  s_mov_b32 exec_hi, 0
  ds_write_b32 v26, v3 offset:2304
  ds_write_b32 v26, v4 offset:2320
  s_mov_b64 exec, -1
  ds_read_b128 v[8:11], v2 offset:1024
  v_mov_b32 v3, 0xff7fffff
  v_mov_b32 v4, 0
  v_mov_b32 v32, 0
  v_mov_b32 v33, 0
  v_mov_b32 v34, 0
  v_mov_b32 v35, 0
  v_mov_b32 v36, 0
  v_mov_b32 v37, 0
  v_mov_b32 v38, 0
  v_mov_b32 v39, 0
  v_mov_b32 v40, 0
  v_mov_b32 v41, 0
  v_mov_b32 v42, 0
  v_mov_b32 v43, 0
  v_mov_b32 v44, 0
  v_mov_b32 v45, 0
  v_mov_b32 v46, 0
  v_mov_b32 v47, 0
  v_mov_b32 v48, 0
  v_mov_b32 v49, 0
  v_mov_b32 v50, 0
  v_mov_b32 v51, 0
  v_mov_b32 v52, 0
  v_mov_b32 v53, 0
  v_mov_b32 v54, 0
  v_mov_b32 v55, 0
  v_mov_b32 v56, 0
  v_mov_b32 v57, 0
  v_mov_b32 v58, 0
  v_mov_b32 v59, 0
  v_mov_b32 v60, 0
  v_mov_b32 v61, 0
  v_mov_b32 v62, 0
  v_mov_b32 v63, 0
  s_waitcnt lgkmcnt(0)
L_NF1:
  s_cmp_eq_u32 s45, 0
  s_cbranch_scc1 L_LOOP
  s_sub_u32 s45, s45, 1
  s_cmp_eq_u32 s45, 0
  s_cbranch_scc1 L_DONE
  s_branch L_LOOP
L_DONE:
  v_mov_b32 v7, v4
  s_nop 1
  v_permlane16_swap_b32 v4, v7
  v_add_f32 v4, v4, v7
  v_mov_b32 v7, v4
  s_nop 1
  v_permlane32_swap_b32 v4, v7
  v_add_f32 v4, v4, v7
  s_mov_b32 exec_lo, 0x11111111
  s_mov_b32 exec_hi, 0x11111111
  ds_write_b128 v25, v[32:35] offset:13312
  ds_write_b128 v25, v[36:39] offset:13328
  ds_write_b128 v25, v[40:43] offset:13344
  ds_write_b128 v25, v[44:47] offset:13360
  ds_write_b128 v25, v[48:51] offset:13376
  ds_write_b128 v25, v[52:55] offset:13392
  ds_write_b128 v25, v[56:59] offset:13408
  ds_write_b128 v25, v[60:63] offset:13424
  s_mov_b32 exec_lo, 0x1111
  s_mov_b32 exec_hi, 0
  ds_write_b32 v26, v3 offset:2432
  ds_write_b32 v26, v4 offset:2448
  s_mov_b64 exec, -1
  v_lshrrev_b32 v10, 5, v0
  s_lshl_b32 s81, s74, 5
  v_lshlrev_b32 v8, 7, v10
  v_add_u32 v8, s81, v8
  v_and_b32 v9, 3, v0
  v_lshlrev_b32 v9, 4, v9
  v_lshl_add_u32 v9, v10, 12, v9
  v_mov_b32 v22, s76
  v_mov_b32 v23, s77
  v_mov_b32 v82, s76
  v_mov_b32 v83, s77
  s_waitcnt lgkmcnt(0)
  s_barrier
  ds_read_b128 v[12:15], v8 offset:2304
  ds_read_b128 v[16:19], v8 offset:2320
  ds_read_b128 v[64:67], v27 offset:4096
  ds_read_b128 v[68:71], v27 offset:6400
  ds_read_b128 v[72:75], v27 offset:8704
  ds_read_b128 v[76:79], v27 offset:11008
  s_waitcnt lgkmcnt(4)
  v_max3_f32 v80, v12, v13, v14
  v_max_f32 v80, v80, v15
  v_sub_f32 v12, v12, v80
  v_sub_f32 v13, v13, v80
  v_sub_f32 v14, v14, v80
  v_sub_f32 v15, v15, v80
  v_exp_f32 v12, v12
  v_exp_f32 v13, v13
  v_exp_f32 v14, v14
  v_exp_f32 v15, v15
  v_mul_f32 v81, v12, v16
  v_fma_f32 v81, v13, v17, v81
  v_fma_f32 v81, v14, v18, v81
  v_fma_f32 v81, v15, v19, v81
  v_rcp_f32 v16, v81
  s_waitcnt lgkmcnt(0)
  v_mul_f32 v64, v12, v64
  v_mul_f32 v65, v12, v65
  v_mul_f32 v66, v12, v66
  v_mul_f32 v67, v12, v67
  v_fma_f32 v64, v13, v68, v64
  v_fma_f32 v65, v13, v69, v65
  v_fma_f32 v66, v13, v70, v66
  v_fma_f32 v67, v13, v71, v67
  v_fma_f32 v64, v14, v72, v64
  v_fma_f32 v65, v14, v73, v65
  v_fma_f32 v66, v14, v74, v66
  v_fma_f32 v67, v14, v75, v67
  v_fma_f32 v64, v15, v76, v64
  v_fma_f32 v65, v15, v77, v65
  v_fma_f32 v66, v15, v78, v66
  v_fma_f32 v67, v15, v79, v67
  v_mul_f32 v64, v16, v64
  v_mul_f32 v65, v16, v65
  v_mul_f32 v66, v16, v66
  v_mul_f32 v67, v16, v67
  v_cvt_pk_bf16_f32 v20, v64, v65
  v_cvt_pk_bf16_f32 v21, v66, v67
  buffer_store_dwordx4 v[20:23], v28, s[52:55], s4 offen sc1
  s_mov_b32 exec_lo, 15
  s_mov_b32 exec_hi, 15
  buffer_store_dwordx4 v[80:83], v9, s[52:55], s6 offen sc1
  s_mov_b64 exec, -1
  s_waitcnt vmcnt(2)
  v_perm_b32 v32, v196, v192, s69
  v_perm_b32 v33, v204, v200, s69
  v_perm_b32 v34, v212, v208, s69
  v_perm_b32 v35, v220, v216, s69
  v_perm_b32 v36, v196, v192, s70
  v_perm_b32 v37, v204, v200, s70
  v_perm_b32 v38, v212, v208, s70
  v_perm_b32 v39, v220, v216, s70
  v_perm_b32 v40, v197, v193, s69
  v_perm_b32 v41, v205, v201, s69
  v_perm_b32 v42, v213, v209, s69
  v_perm_b32 v43, v221, v217, s69
  v_perm_b32 v44, v197, v193, s70
  v_perm_b32 v45, v205, v201, s70
  v_perm_b32 v46, v213, v209, s70
  v_perm_b32 v47, v221, v217, s70
  v_perm_b32 v48, v198, v194, s69
  v_perm_b32 v49, v206, v202, s69
  v_perm_b32 v50, v214, v210, s69
  v_perm_b32 v51, v222, v218, s69
  v_perm_b32 v52, v198, v194, s70
  v_perm_b32 v53, v206, v202, s70
  v_perm_b32 v54, v214, v210, s70
  v_perm_b32 v55, v222, v218, s70
  v_perm_b32 v56, v199, v195, s69
  v_perm_b32 v57, v207, v203, s69
  v_perm_b32 v58, v215, v211, s69
  v_perm_b32 v59, v223, v219, s69
  v_perm_b32 v60, v199, v195, s70
  v_perm_b32 v61, v207, v203, s70
  v_perm_b32 v62, v215, v211, s70
  v_perm_b32 v63, v223, v219, s70
  v_mov_b32 v86, s76
  v_mov_b32 v87, s77
  s_barrier
  ds_read_b128 v[92:95], v31 offset:2560
  s_waitcnt lgkmcnt(0)
  v_mfma_f32_16x16x32_bf16 v[96:99], v[92:95], v[32:35], 0
  v_mfma_f32_16x16x32_bf16 v[100:103], v[92:95], v[36:39], 0
  v_mfma_f32_16x16x32_bf16 v[104:107], v[92:95], v[40:43], 0
  v_mfma_f32_16x16x32_bf16 v[108:111], v[92:95], v[44:47], 0
  v_mfma_f32_16x16x32_bf16 v[112:115], v[92:95], v[48:51], 0
  v_mfma_f32_16x16x32_bf16 v[116:119], v[92:95], v[52:55], 0
  v_mfma_f32_16x16x32_bf16 v[120:123], v[92:95], v[56:59], 0
  v_mfma_f32_16x16x32_bf16 v[124:127], v[92:95], v[60:63], 0
  s_nop 1
  v_cvt_pk_bf16_f32 v128, v96, v100
  v_cvt_pk_bf16_f32 v132, v97, v101
  v_cvt_pk_bf16_f32 v129, v104, v108
  v_cvt_pk_bf16_f32 v133, v105, v109
  v_cvt_pk_bf16_f32 v130, v112, v116
  v_cvt_pk_bf16_f32 v134, v113, v117
  v_cvt_pk_bf16_f32 v131, v120, v124
  v_cvt_pk_bf16_f32 v135, v121, v125
  v_cndmask_b32 v88, v128, v130, s[84:85]
  v_cndmask_b32 v89, v132, v134, s[84:85]
  v_cndmask_b32 v90, v129, v131, s[84:85]
  v_cndmask_b32 v91, v133, v135, s[84:85]
  v_cndmask_b32 v136, v88, v89, s[86:87]
  v_cndmask_b32 v137, v90, v91, s[86:87]
  ds_bpermute_b32 v84, v30, v136
  ds_bpermute_b32 v85, v30, v137
  s_waitcnt lgkmcnt(0)
  buffer_store_dwordx4 v[84:87], v29, s[52:55], s12 offen sc1
  s_endpgm
L_QP:
  v_lshrrev_b32 v4, 4, v0
  v_bfe_u32 v5, v0, 2, 2
  v_and_b32 v6, 3, v0
  v_lshlrev_b32 v7, 2, v4
  v_add_u32 v7, v7, v5
  v_lshlrev_b32 v7, 16, v7
  v_lshl_add_u32 v7, v6, 4, v7
  v_bfe_u32 v8, v0, 2, 1
  v_lshlrev_b32 v8, 10, v8
  v_lshl_add_u32 v8, v4, 6, v8
  v_lshl_add_u32 v8, v6, 4, v8
  s_lshl_b32 s81, s72, 10
  s_lshl_b32 s82, s80, 6
  s_add_u32 s81, s81, s82
  s_mov_b32 s34, 4186176
  s_mov_b32 s35, 0x20000
  s_mov_b32 s46, 2048
  s_mov_b32 s47, 0x20000
  s_mov_b32 s54, 0x1000000
  s_mov_b32 s55, 0x20000
  s_waitcnt lgkmcnt(0)
  s_mov_b32 s52, s28
  s_mov_b32 s53, s29
  s_cmp_eq_u32 s79, 0
  s_cselect_b32 s32, s10, s20
  s_cselect_b32 s33, s11, s21
  s_cselect_b32 s44, s4, s14
  s_cselect_b32 s45, s5, s15
  s_add_u32 s32, s32, s81
  s_addc_u32 s33, s33, 0
  buffer_load_dwordx4 v[16:19], v8, s[44:47], 0 offen offset:0
  buffer_load_dwordx4 v[20:23], v8, s[44:47], 0 offen offset:256
  buffer_load_dwordx4 v[24:27], v8, s[44:47], 0 offen offset:512
  buffer_load_dwordx4 v[28:31], v8, s[44:47], 0 offen offset:768
  s_mov_b32 s83, 0
  buffer_load_dwordx4 v[32:35], v7, s[32:35], s83 offen nt
  s_mov_b32 s83, 8192
  buffer_load_dwordx4 v[36:39], v7, s[32:35], s83 offen nt
  s_mov_b32 s83, 16384
  buffer_load_dwordx4 v[40:43], v7, s[32:35], s83 offen nt
  s_mov_b32 s83, 24576
  buffer_load_dwordx4 v[44:47], v7, s[32:35], s83 offen nt
  s_mov_b32 s83, 32768
  buffer_load_dwordx4 v[48:51], v7, s[32:35], s83 offen nt
  s_mov_b32 s83, 40960
  buffer_load_dwordx4 v[52:55], v7, s[32:35], s83 offen nt
  s_mov_b32 s83, 49152
  buffer_load_dwordx4 v[56:59], v7, s[32:35], s83 offen nt
  s_mov_b32 s83, 57344
  buffer_load_dwordx4 v[60:63], v7, s[32:35], s83 offen nt
  s_mov_b32 s83, 1048576
  buffer_load_dwordx4 v[64:67], v7, s[32:35], s83 offen nt
  s_mov_b32 s83, 1056768
  buffer_load_dwordx4 v[68:71], v7, s[32:35], s83 offen nt
  s_mov_b32 s83, 1064960
  buffer_load_dwordx4 v[72:75], v7, s[32:35], s83 offen nt
  s_mov_b32 s83, 1073152
  buffer_load_dwordx4 v[76:79], v7, s[32:35], s83 offen nt
  s_mov_b32 s83, 1081344
  buffer_load_dwordx4 v[80:83], v7, s[32:35], s83 offen nt
  s_mov_b32 s83, 1089536
  buffer_load_dwordx4 v[84:87], v7, s[32:35], s83 offen nt
  s_mov_b32 s83, 1097728
  buffer_load_dwordx4 v[88:91], v7, s[32:35], s83 offen nt
  s_mov_b32 s83, 1105920
  buffer_load_dwordx4 v[92:95], v7, s[32:35], s83 offen nt
  s_mov_b32 s83, 2097152
  buffer_load_dwordx4 v[96:99], v7, s[32:35], s83 offen nt
  s_mov_b32 s83, 2105344
  buffer_load_dwordx4 v[100:103], v7, s[32:35], s83 offen nt
  s_mov_b32 s83, 2113536
  buffer_load_dwordx4 v[104:107], v7, s[32:35], s83 offen nt
  s_mov_b32 s83, 2121728
  buffer_load_dwordx4 v[108:111], v7, s[32:35], s83 offen nt
  s_mov_b32 s83, 2129920
  buffer_load_dwordx4 v[112:115], v7, s[32:35], s83 offen nt
  s_mov_b32 s83, 2138112
  buffer_load_dwordx4 v[116:119], v7, s[32:35], s83 offen nt
  s_mov_b32 s83, 2146304
  buffer_load_dwordx4 v[120:123], v7, s[32:35], s83 offen nt
  s_mov_b32 s83, 2154496
  buffer_load_dwordx4 v[124:127], v7, s[32:35], s83 offen nt
  s_mov_b32 s83, 3145728
  buffer_load_dwordx4 v[128:131], v7, s[32:35], s83 offen nt
  s_mov_b32 s83, 3153920
  buffer_load_dwordx4 v[132:135], v7, s[32:35], s83 offen nt
  s_mov_b32 s83, 3162112
  buffer_load_dwordx4 v[136:139], v7, s[32:35], s83 offen nt
  s_mov_b32 s83, 3170304
  buffer_load_dwordx4 v[140:143], v7, s[32:35], s83 offen nt
  s_mov_b32 s83, 3178496
  buffer_load_dwordx4 v[144:147], v7, s[32:35], s83 offen nt
  s_mov_b32 s83, 3186688
  buffer_load_dwordx4 v[148:151], v7, s[32:35], s83 offen nt
  s_mov_b32 s83, 3194880
  buffer_load_dwordx4 v[152:155], v7, s[32:35], s83 offen nt
  s_mov_b32 s83, 3203072
  buffer_load_dwordx4 v[156:159], v7, s[32:35], s83 offen nt
  s_barrier
  s_waitcnt vmcnt(24)
  s_barrier
  s_lshl_b32 s81, s72, 1
  s_add_u32 s81, s81, s79
  s_lshl_b32 s81, s81, 4
  s_add_u32 s81, s81, s80
  s_lshl_b32 s81, s81, 8
  v_bfe_u32 v9, v0, 4, 1
  v_lshlrev_b32 v9, 7, v9
  v_lshl_add_u32 v9, v6, 4, v9
  v_bfe_u32 v10, v0, 2, 1
  v_lshl_add_u32 v9, v10, 6, v9
  v_and_b32 v10, 4, v0
  v_cmp_ne_u32 s[58:59], 0, v10
  v_and_b32 v10, 8, v0
  v_cmp_ne_u32 s[82:83], 0, v10
  v_mov_b32 v11, 2048
  s_mov_b32 s56, 0
L_QC:
  s_cmp_eq_u32 s56, 0
  s_cbranch_scc1 L_QW0
  s_waitcnt vmcnt(24)
L_QW0:
  v_perm_b32 v192, v36, v32, s69
  v_perm_b32 v193, v44, v40, s69
  v_perm_b32 v194, v52, v48, s69
  v_perm_b32 v195, v60, v56, s69
  v_perm_b32 v196, v36, v32, s70
  v_perm_b32 v197, v44, v40, s70
  v_perm_b32 v198, v52, v48, s70
  v_perm_b32 v199, v60, v56, s70
  v_mfma_f32_16x16x32_bf16 v[160:163], v[16:19], v[192:195], 0
  v_perm_b32 v192, v37, v33, s69
  v_perm_b32 v193, v45, v41, s69
  v_perm_b32 v194, v53, v49, s69
  v_perm_b32 v195, v61, v57, s69
  v_mfma_f32_16x16x32_bf16 v[164:167], v[16:19], v[196:199], 0
  v_perm_b32 v196, v37, v33, s70
  v_perm_b32 v197, v45, v41, s70
  v_perm_b32 v198, v53, v49, s70
  v_perm_b32 v199, v61, v57, s70
  v_mfma_f32_16x16x32_bf16 v[168:171], v[16:19], v[192:195], 0
  v_perm_b32 v192, v38, v34, s69
  v_perm_b32 v193, v46, v42, s69
  v_perm_b32 v194, v54, v50, s69
  v_perm_b32 v195, v62, v58, s69
  v_mfma_f32_16x16x32_bf16 v[172:175], v[16:19], v[196:199], 0
  v_perm_b32 v196, v38, v34, s70
  v_perm_b32 v197, v46, v42, s70
  v_perm_b32 v198, v54, v50, s70
  v_perm_b32 v199, v62, v58, s70
  v_mfma_f32_16x16x32_bf16 v[176:179], v[16:19], v[192:195], 0
  v_perm_b32 v192, v39, v35, s69
  v_perm_b32 v193, v47, v43, s69
  v_perm_b32 v194, v55, v51, s69
  v_perm_b32 v195, v63, v59, s69
  v_mfma_f32_16x16x32_bf16 v[180:183], v[16:19], v[196:199], 0
  v_perm_b32 v196, v39, v35, s70
  v_perm_b32 v197, v47, v43, s70
  v_perm_b32 v198, v55, v51, s70
  v_perm_b32 v199, v63, v59, s70
  v_mfma_f32_16x16x32_bf16 v[184:187], v[16:19], v[192:195], 0
  s_cmp_eq_u32 s56, 0
  s_cbranch_scc1 L_QW1
  s_waitcnt vmcnt(16)
L_QW1:
  v_perm_b32 v192, v68, v64, s69
  v_perm_b32 v193, v76, v72, s69
  v_perm_b32 v194, v84, v80, s69
  v_perm_b32 v195, v92, v88, s69
  v_mfma_f32_16x16x32_bf16 v[188:191], v[16:19], v[196:199], 0
  v_perm_b32 v196, v68, v64, s70
  v_perm_b32 v197, v76, v72, s70
  v_perm_b32 v198, v84, v80, s70
  v_perm_b32 v199, v92, v88, s70
  v_mfma_f32_16x16x32_bf16 v[160:163], v[20:23], v[192:195], v[160:163]
  v_perm_b32 v192, v69, v65, s69
  v_perm_b32 v193, v77, v73, s69
  v_perm_b32 v194, v85, v81, s69
  v_perm_b32 v195, v93, v89, s69
  v_mfma_f32_16x16x32_bf16 v[164:167], v[20:23], v[196:199], v[164:167]
  v_perm_b32 v196, v69, v65, s70
  v_perm_b32 v197, v77, v73, s70
  v_perm_b32 v198, v85, v81, s70
  v_perm_b32 v199, v93, v89, s70
  v_mfma_f32_16x16x32_bf16 v[168:171], v[20:23], v[192:195], v[168:171]
  v_perm_b32 v192, v70, v66, s69
  v_perm_b32 v193, v78, v74, s69
  v_perm_b32 v194, v86, v82, s69
  v_perm_b32 v195, v94, v90, s69
  v_mfma_f32_16x16x32_bf16 v[172:175], v[20:23], v[196:199], v[172:175]
  v_perm_b32 v196, v70, v66, s70
  v_perm_b32 v197, v78, v74, s70
  v_perm_b32 v198, v86, v82, s70
  v_perm_b32 v199, v94, v90, s70
  v_mfma_f32_16x16x32_bf16 v[176:179], v[20:23], v[192:195], v[176:179]
  v_perm_b32 v192, v71, v67, s69
  v_perm_b32 v193, v79, v75, s69
  v_perm_b32 v194, v87, v83, s69
  v_perm_b32 v195, v95, v91, s69
  v_mfma_f32_16x16x32_bf16 v[180:183], v[20:23], v[196:199], v[180:183]
  v_perm_b32 v196, v71, v67, s70
  v_perm_b32 v197, v79, v75, s70
  v_perm_b32 v198, v87, v83, s70
  v_perm_b32 v199, v95, v91, s70
  v_mfma_f32_16x16x32_bf16 v[184:187], v[20:23], v[192:195], v[184:187]
  s_cmp_eq_u32 s56, 0
  s_cbranch_scc1 L_QW2
  s_waitcnt vmcnt(8)
L_QW2:
  v_perm_b32 v192, v100, v96, s69
  v_perm_b32 v193, v108, v104, s69
  v_perm_b32 v194, v116, v112, s69
  v_perm_b32 v195, v124, v120, s69
  v_mfma_f32_16x16x32_bf16 v[188:191], v[20:23], v[196:199], v[188:191]
  v_perm_b32 v196, v100, v96, s70
  v_perm_b32 v197, v108, v104, s70
  v_perm_b32 v198, v116, v112, s70
  v_perm_b32 v199, v124, v120, s70
  v_mfma_f32_16x16x32_bf16 v[160:163], v[24:27], v[192:195], v[160:163]
  v_perm_b32 v192, v101, v97, s69
  v_perm_b32 v193, v109, v105, s69
  v_perm_b32 v194, v117, v113, s69
  v_perm_b32 v195, v125, v121, s69
  v_mfma_f32_16x16x32_bf16 v[164:167], v[24:27], v[196:199], v[164:167]
  v_perm_b32 v196, v101, v97, s70
  v_perm_b32 v197, v109, v105, s70
  v_perm_b32 v198, v117, v113, s70
  v_perm_b32 v199, v125, v121, s70
  v_mfma_f32_16x16x32_bf16 v[168:171], v[24:27], v[192:195], v[168:171]
  v_perm_b32 v192, v102, v98, s69
  v_perm_b32 v193, v110, v106, s69
  v_perm_b32 v194, v118, v114, s69
  v_perm_b32 v195, v126, v122, s69
  v_mfma_f32_16x16x32_bf16 v[172:175], v[24:27], v[196:199], v[172:175]
  v_perm_b32 v196, v102, v98, s70
  v_perm_b32 v197, v110, v106, s70
  v_perm_b32 v198, v118, v114, s70
  v_perm_b32 v199, v126, v122, s70
  v_mfma_f32_16x16x32_bf16 v[176:179], v[24:27], v[192:195], v[176:179]
  v_perm_b32 v192, v103, v99, s69
  v_perm_b32 v193, v111, v107, s69
  v_perm_b32 v194, v119, v115, s69
  v_perm_b32 v195, v127, v123, s69
  v_mfma_f32_16x16x32_bf16 v[180:183], v[24:27], v[196:199], v[180:183]
  v_perm_b32 v196, v103, v99, s70
  v_perm_b32 v197, v111, v107, s70
  v_perm_b32 v198, v119, v115, s70
  v_perm_b32 v199, v127, v123, s70
  v_mfma_f32_16x16x32_bf16 v[184:187], v[24:27], v[192:195], v[184:187]
  s_cmp_eq_u32 s56, 0
  s_cbranch_scc1 L_QW3
  s_waitcnt vmcnt(0)
L_QW3:
  v_perm_b32 v192, v132, v128, s69
  v_perm_b32 v193, v140, v136, s69
  v_perm_b32 v194, v148, v144, s69
  v_perm_b32 v195, v156, v152, s69
  v_mfma_f32_16x16x32_bf16 v[188:191], v[24:27], v[196:199], v[188:191]
  v_perm_b32 v196, v132, v128, s70
  v_perm_b32 v197, v140, v136, s70
  v_perm_b32 v198, v148, v144, s70
  v_perm_b32 v199, v156, v152, s70
  v_mfma_f32_16x16x32_bf16 v[160:163], v[28:31], v[192:195], v[160:163]
  v_perm_b32 v192, v133, v129, s69
  v_perm_b32 v193, v141, v137, s69
  v_perm_b32 v194, v149, v145, s69
  v_perm_b32 v195, v157, v153, s69
  v_mfma_f32_16x16x32_bf16 v[164:167], v[28:31], v[196:199], v[164:167]
  v_perm_b32 v196, v133, v129, s70
  v_perm_b32 v197, v141, v137, s70
  v_perm_b32 v198, v149, v145, s70
  v_perm_b32 v199, v157, v153, s70
  v_mfma_f32_16x16x32_bf16 v[168:171], v[28:31], v[192:195], v[168:171]
  v_perm_b32 v192, v134, v130, s69
  v_perm_b32 v193, v142, v138, s69
  v_perm_b32 v194, v150, v146, s69
  v_perm_b32 v195, v158, v154, s69
  v_mfma_f32_16x16x32_bf16 v[172:175], v[28:31], v[196:199], v[172:175]
  v_perm_b32 v196, v134, v130, s70
  v_perm_b32 v197, v142, v138, s70
  v_perm_b32 v198, v150, v146, s70
  v_perm_b32 v199, v158, v154, s70
  v_mfma_f32_16x16x32_bf16 v[176:179], v[28:31], v[192:195], v[176:179]
  v_perm_b32 v192, v135, v131, s69
  v_perm_b32 v193, v143, v139, s69
  v_perm_b32 v194, v151, v147, s69
  v_perm_b32 v195, v159, v155, s69
  v_mfma_f32_16x16x32_bf16 v[180:183], v[28:31], v[196:199], v[180:183]
  v_perm_b32 v196, v135, v131, s70
  v_perm_b32 v197, v143, v139, s70
  v_perm_b32 v198, v151, v147, s70
  v_perm_b32 v199, v159, v155, s70
  v_mfma_f32_16x16x32_bf16 v[184:187], v[28:31], v[192:195], v[184:187]
  s_nop 0
  v_mfma_f32_16x16x32_bf16 v[188:191], v[28:31], v[196:199], v[188:191]
  v_cndmask_b32 v208, v160, v161, s[58:59]
  v_cndmask_b32 v209, v162, v163, s[58:59]
  v_cndmask_b32 v200, v208, v209, s[82:83]
  v_cndmask_b32 v208, v164, v165, s[58:59]
  v_cndmask_b32 v209, v166, v167, s[58:59]
  v_cndmask_b32 v201, v208, v209, s[82:83]
  v_cndmask_b32 v208, v168, v169, s[58:59]
  v_cndmask_b32 v209, v170, v171, s[58:59]
  v_cndmask_b32 v202, v208, v209, s[82:83]
  v_cndmask_b32 v208, v172, v173, s[58:59]
  v_cndmask_b32 v209, v174, v175, s[58:59]
  v_cndmask_b32 v203, v208, v209, s[82:83]
  v_cndmask_b32 v208, v176, v177, s[58:59]
  v_cndmask_b32 v209, v178, v179, s[58:59]
  v_cndmask_b32 v204, v208, v209, s[82:83]
  v_cndmask_b32 v208, v180, v181, s[58:59]
  v_cndmask_b32 v209, v182, v183, s[58:59]
  v_cndmask_b32 v205, v208, v209, s[82:83]
  v_cndmask_b32 v208, v184, v185, s[58:59]
  v_cndmask_b32 v209, v186, v187, s[58:59]
  v_cndmask_b32 v206, v208, v209, s[82:83]
  v_cndmask_b32 v208, v188, v189, s[58:59]
  v_cndmask_b32 v209, v190, v191, s[58:59]
  v_cndmask_b32 v207, v208, v209, s[82:83]
  v_add_f32_dpp v200, v200, v200 row_ror:4 row_mask:0xf bank_mask:0xf
  v_add_f32_dpp v201, v201, v201 row_ror:4 row_mask:0xf bank_mask:0xf
  v_add_f32_dpp v202, v202, v202 row_ror:4 row_mask:0xf bank_mask:0xf
  v_add_f32_dpp v203, v203, v203 row_ror:4 row_mask:0xf bank_mask:0xf
  v_add_f32_dpp v204, v204, v204 row_ror:4 row_mask:0xf bank_mask:0xf
  v_add_f32_dpp v205, v205, v205 row_ror:4 row_mask:0xf bank_mask:0xf
  v_add_f32_dpp v206, v206, v206 row_ror:4 row_mask:0xf bank_mask:0xf
  v_add_f32_dpp v207, v207, v207 row_ror:4 row_mask:0xf bank_mask:0xf
  v_add_f32_dpp v200, v200, v200 row_ror:8 row_mask:0xf bank_mask:0xf
  v_add_f32_dpp v201, v201, v201 row_ror:8 row_mask:0xf bank_mask:0xf
  v_add_f32_dpp v202, v202, v202 row_ror:8 row_mask:0xf bank_mask:0xf
  v_add_f32_dpp v203, v203, v203 row_ror:8 row_mask:0xf bank_mask:0xf
  v_add_f32_dpp v204, v204, v204 row_ror:8 row_mask:0xf bank_mask:0xf
  v_add_f32_dpp v205, v205, v205 row_ror:8 row_mask:0xf bank_mask:0xf
  v_add_f32_dpp v206, v206, v206 row_ror:8 row_mask:0xf bank_mask:0xf
  v_add_f32_dpp v207, v207, v207 row_ror:8 row_mask:0xf bank_mask:0xf
  v_cvt_pk_bf16_f32 v212, v200, v201
  v_cvt_pk_bf16_f32 v213, v202, v203
  v_cvt_pk_bf16_f32 v214, v204, v205
  v_cvt_pk_bf16_f32 v215, v206, v207
  v_cndmask_b32 v216, v212, v214, s[58:59]
  v_cndmask_b32 v217, v213, v215, s[58:59]
  s_add_u32 s56, s56, 1
  s_cmp_eq_u32 s56, 1
  s_cbranch_scc1 L_QC
  s_mov_b32 s57, 1600000
L_QN:
  ds_read_b64 v[218:219], v11
  s_waitcnt lgkmcnt(0)
  v_readfirstlane_b32 s76, v218
  s_nop 0
  s_cmp_lg_u32 s76, 0
  s_cbranch_scc1 L_QND
  s_sleep 1
  s_sub_u32 s57, s57, 1
  s_cmp_eq_u32 s57, 0
  s_cbranch_scc0 L_QN
L_QND:
  s_mov_b32 exec_lo, 0x00ff00ff
  s_mov_b32 exec_hi, 0
  buffer_store_dwordx4 v[216:219], v9, s[52:55], s81 offen sc1
  s_mov_b64 exec, -1
  v_mov_b32 v12, 1
  ds_write_b32 v11, v12 offset:16
  s_waitcnt lgkmcnt(0)
  s_endpgm
L_AUX:
  v_lshrrev_b32 v4, 4, v0
  v_and_b32 v6, 3, v0
  v_mov_b32 v1, 0
  v_mov_b32 v2, 0
  v_mov_b32 v3, 0
  v_mov_b32 v8, 2048
  ds_write_b64 v8, v[2:3]
  ds_write_b32 v8, v1 offset:16
  s_mov_b32 s38, 256
  s_mov_b32 s39, 0x20000
  s_mov_b32 s54, 0x1000000
  s_mov_b32 s55, 0x20000
  s_waitcnt lgkmcnt(0)
  s_mov_b32 s36, s26
  s_mov_b32 s37, s27
  s_mov_b32 s52, s28
  s_mov_b32 s53, s29
  s_cmp_eq_u32 s2, 0
  s_cbranch_scc0 L_NOLEAD
  s_or_b32 s76, s76, 1
  v_mov_b32 v2, s76
  v_mov_b32 v3, s77
  s_mov_b64 exec, 1
  buffer_store_dwordx2 v[2:3], v1, s[36:39], 0 offen sc1
  s_mov_b64 exec, -1
L_NOLEAD:
  v_bfe_u32 v9, v0, 2, 2
  v_lshlrev_b32 v9, 2, v9
  v_add_u32 v9, v9, v4
  v_lshlrev_b32 v9, 8, v9
  v_lshl_add_u32 v9, v6, 4, v9
  s_lshl_b32 s81, s72, 13
  s_lshl_b32 s82, s71, 7
  s_add_u32 s81, s81, s82
  s_add_u32 s82, s81, 4096
  s_barrier
  buffer_load_dwordx2 v[2:3], v1, s[36:39], 0 offen
  s_barrier
  s_mov_b32 s57, 200000
  s_waitcnt vmcnt(0)
  s_cmp_eq_u32 s2, 0
  s_cbranch_scc1 L_NPD
  v_readfirstlane_b32 s76, v2
  v_readfirstlane_b32 s77, v3
  s_cmp_lg_u32 s76, 0
  s_cbranch_scc1 L_NPD
L_NP:
  buffer_load_dwordx2 v[2:3], v1, s[36:39], 0 offen sc1
  s_waitcnt vmcnt(0)
  v_readfirstlane_b32 s76, v2
  v_readfirstlane_b32 s77, v3
  s_cmp_lg_u32 s76, 0
  s_cbranch_scc1 L_NPD
  s_sub_u32 s57, s57, 1
  s_cmp_eq_u32 s57, 0
  s_cbranch_scc0 L_NP
L_NPD:
  v_mov_b32 v2, s76
  v_mov_b32 v3, s77
  ds_write_b64 v8, v[2:3]
  s_mov_b32 s57, 1600000
L_QF:
  ds_read_b32 v2, v8 offset:16
  s_waitcnt lgkmcnt(0)
  v_readfirstlane_b32 s56, v2
  s_nop 0
  s_cmp_lg_u32 s56, 0
  s_cbranch_scc1 L_QFD
  s_sleep 1
  s_sub_u32 s57, s57, 1
  s_cmp_eq_u32 s57, 0
  s_cbranch_scc0 L_QF
L_QFD:
  s_sleep 24
  s_mov_b64 s[60:61], exec
  s_mov_b64 s[62:63], exec
  s_mov_b64 s[64:65], exec
  s_mov_b64 s[66:67], exec
  s_mov_b32 s57, 200000
L_QG:
  s_mov_b64 exec, s[60:61]
  s_cbranch_execz L_QG_k0
  buffer_load_dwordx4 v[224:227], v9, s[52:55], s81 offen offset:0 sc1
L_QG_k0:
  s_mov_b64 exec, s[62:63]
  s_cbranch_execz L_QG_k1
  buffer_load_dwordx4 v[228:231], v9, s[52:55], s81 offen offset:64 sc1
L_QG_k1:
  s_mov_b64 exec, s[64:65]
  s_cbranch_execz L_QG_k2
  buffer_load_dwordx4 v[232:235], v9, s[52:55], s82 offen offset:0 sc1
L_QG_k2:
  s_mov_b64 exec, s[66:67]
  s_cbranch_execz L_QG_k3
  buffer_load_dwordx4 v[236:239], v9, s[52:55], s82 offen offset:64 sc1
L_QG_k3:
  s_waitcnt vmcnt(0)
  s_mov_b64 exec, s[60:61]
  v_cmp_ne_u64 s[60:61], v[226:227], s[76:77]
  s_mov_b64 exec, s[62:63]
  v_cmp_ne_u64 s[62:63], v[230:231], s[76:77]
  s_mov_b64 exec, s[64:65]
  v_cmp_ne_u64 s[64:65], v[234:235], s[76:77]
  s_mov_b64 exec, s[66:67]
  v_cmp_ne_u64 s[66:67], v[238:239], s[76:77]
  s_mov_b64 exec, -1
  s_or_b64 s[58:59], s[60:61], s[62:63]
  s_or_b64 s[58:59], s[58:59], s[64:65]
  s_or_b64 s[58:59], s[58:59], s[66:67]
  s_cmp_eq_u64 s[58:59], 0
  s_cbranch_scc1 L_QGD
  s_bcnt1_i32_b64 s56, s[58:59]
  s_cmp_gt_u32 s56, 24
  s_cbranch_scc0 L_QG_s
  s_sleep 4
L_QG_s:
  s_sub_u32 s57, s57, 1
  s_cmp_eq_u32 s57, 0
  s_cbranch_scc0 L_QG
L_QGD:
  v_mov_b32 v226, v228
  v_mov_b32 v227, v229
  v_mov_b32 v234, v236
  v_mov_b32 v235, v237
  v_lshlrev_b32 v9, 4, v0
  ds_write_b128 v9, v[224:227] offset:0
  ds_write_b128 v9, v[232:235] offset:1024
  s_waitcnt lgkmcnt(0)
  s_barrier
  s_lshl_b32 s82, s72, 1
  s_add_u32 s82, s82, s79
  s_lshl_b32 s81, s82, 4
  s_add_u32 s81, s81, s80
  s_lshl_b32 s81, s81, 12
  s_add_u32 s8, s81, 1048576
  s_lshl_b32 s82, s82, 2
  s_lshr_b32 s83, s80, 2
  s_add_u32 s82, s82, s83
  s_lshl_b32 s82, s82, 10
  s_add_u32 s9, s82, 3145728
  s_add_u32 s10, s9, 65536
  s_lshl_b32 s11, s72, 4
  s_add_u32 s11, s11, s80
  s_lshr_b32 s19, s11, 1
  s_lshl_b32 s81, s79, 19
  s_add_u32 s81, s81, 4194304
  s_lshl_b32 s82, s19, 13
  s_add_u32 s13, s81, s82
  s_add_u32 s18, s13, 4096
  s_lshr_b32 s81, s19, 5
  s_lshl_b32 s81, s81, 11
  s_lshl_b32 s82, s79, 10
  s_add_u32 s81, s81, s82
  s_and_b32 s82, s19, 31
  s_lshl_b32 s82, s82, 5
  s_add_u32 s14, s81, s82
  v_lshlrev_b32 v10, 4, v0
  v_lshrrev_b32 v11, 4, v0
  v_lshl_add_u32 v11, v11, 1, v0
  v_and_b32 v11, 15, v11
  v_lshlrev_b32 v11, 6, v11
  v_and_b32 v12, 7, v0
  v_lshlrev_b32 v12, 3, v12
  v_bfe_u32 v13, v0, 3, 1
  v_lshl_add_u32 v12, v13, 2, v12
  v_cmp_ne_u32 s[84:85], 0, v13
  v_lshlrev_b32 v13, 3, v0
  s_barrier
  s_sleep 22
  s_mov_b64 s[32:33], exec
  s_mov_b64 s[34:35], exec
  s_mov_b64 s[36:37], exec
  s_mov_b64 s[38:39], exec
  s_mov_b64 s[40:41], exec
  s_mov_b64 s[42:43], exec
  s_mov_b32 s57, 200000
L_H1:
  s_mov_b64 exec, s[32:33]
  s_cbranch_execz L_H1_k0
  buffer_load_dwordx4 v[48:51], v11, s[52:55], s9 offen sc1
L_H1_k0:
  s_mov_b64 exec, s[34:35]
  s_cbranch_execz L_H1_k1
  buffer_load_dwordx4 v[52:55], v11, s[52:55], s10 offen sc1
L_H1_k1:
  s_mov_b64 exec, s[36:37]
  s_cbranch_execz L_H1_k2
  buffer_load_dwordx4 v[16:19], v10, s[52:55], s8 offen offset:0 sc1
L_H1_k2:
  s_mov_b64 exec, s[38:39]
  s_cbranch_execz L_H1_k3
  buffer_load_dwordx4 v[20:23], v10, s[52:55], s8 offen offset:1024 sc1
L_H1_k3:
  s_mov_b64 exec, s[40:41]
  s_cbranch_execz L_H1_k4
  buffer_load_dwordx4 v[24:27], v10, s[52:55], s8 offen offset:2048 sc1
L_H1_k4:
  s_mov_b64 exec, s[42:43]
  s_cbranch_execz L_H1_k5
  buffer_load_dwordx4 v[28:31], v10, s[52:55], s8 offen offset:3072 sc1
L_H1_k5:
  s_waitcnt vmcnt(0)
  s_mov_b64 exec, s[32:33]
  v_cmp_ne_u64 s[32:33], v[50:51], s[76:77]
  s_mov_b64 exec, s[34:35]
  v_cmp_ne_u64 s[34:35], v[54:55], s[76:77]
  s_mov_b64 exec, s[36:37]
  v_cmp_ne_u64 s[36:37], v[18:19], s[76:77]
  s_mov_b64 exec, s[38:39]
  v_cmp_ne_u64 s[38:39], v[22:23], s[76:77]
  s_mov_b64 exec, s[40:41]
  v_cmp_ne_u64 s[40:41], v[26:27], s[76:77]
  s_mov_b64 exec, s[42:43]
  v_cmp_ne_u64 s[42:43], v[30:31], s[76:77]
  s_mov_b64 exec, -1
  s_or_b64 s[58:59], s[32:33], s[34:35]
  s_or_b64 s[58:59], s[58:59], s[36:37]
  s_or_b64 s[58:59], s[58:59], s[38:39]
  s_or_b64 s[58:59], s[58:59], s[40:41]
  s_or_b64 s[58:59], s[58:59], s[42:43]
  s_cmp_eq_u64 s[58:59], 0
  s_cbranch_scc1 L_H1D
  s_bcnt1_i32_b64 s56, s[58:59]
  s_cmp_gt_u32 s56, 24
  s_cbranch_scc0 L_H1_s
  s_sleep 8
L_H1_s:
  s_sub_u32 s57, s57, 1
  s_cmp_eq_u32 s57, 0
  s_cbranch_scc0 L_H1
L_H1D:
  v_mov_b32 v56, v48
  v_mov_b32 v57, v52
  s_nop 0
  v_max_f32_dpp v56, v56, v56 row_ror:8 row_mask:0xf bank_mask:0xf
  v_max_f32_dpp v57, v57, v57 row_ror:8 row_mask:0xf bank_mask:0xf
  v_lshlrev_b32 v32, 16, v16
  v_and_b32 v33, 0xffff0000, v16
  v_lshlrev_b32 v34, 16, v17
  v_and_b32 v35, 0xffff0000, v17
  v_max_f32_dpp v56, v56, v56 row_ror:4 row_mask:0xf bank_mask:0xf
  v_max_f32_dpp v57, v57, v57 row_ror:4 row_mask:0xf bank_mask:0xf
  v_lshlrev_b32 v36, 16, v20
  v_and_b32 v37, 0xffff0000, v20
  v_lshlrev_b32 v38, 16, v21
  v_and_b32 v39, 0xffff0000, v21
  v_max_f32_dpp v56, v56, v56 row_ror:2 row_mask:0xf bank_mask:0xf
  v_max_f32_dpp v57, v57, v57 row_ror:2 row_mask:0xf bank_mask:0xf
  v_lshlrev_b32 v40, 16, v24
  v_and_b32 v41, 0xffff0000, v24
  v_lshlrev_b32 v42, 16, v25
  v_and_b32 v43, 0xffff0000, v25
  v_max_f32_dpp v56, v56, v56 row_ror:1 row_mask:0xf bank_mask:0xf
  v_max_f32_dpp v57, v57, v57 row_ror:1 row_mask:0xf bank_mask:0xf
  v_lshlrev_b32 v44, 16, v28
  v_and_b32 v45, 0xffff0000, v28
  v_lshlrev_b32 v46, 16, v29
  v_and_b32 v47, 0xffff0000, v29
  v_sub_f32 v48, v48, v56
  v_sub_f32 v52, v52, v57
  v_exp_f32 v48, v48
  v_exp_f32 v52, v52
  v_mul_f32 v48, v48, v49
  v_mul_f32 v52, v52, v53
  v_mov_b32 v58, v48
  v_mov_b32 v59, v52
  v_mov_b32_dpp v60, v48 row_newbcast:0 row_mask:0xf bank_mask:0x3
  v_mov_b32_dpp v60, v48 row_newbcast:1 row_mask:0xf bank_mask:0xc
  v_add_f32_dpp v58, v58, v58 row_ror:8 row_mask:0xf bank_mask:0xf
  v_add_f32_dpp v59, v59, v59 row_ror:8 row_mask:0xf bank_mask:0xf
  v_mov_b32_dpp v61, v48 row_newbcast:8 row_mask:0xf bank_mask:0x3
  v_mov_b32_dpp v61, v48 row_newbcast:9 row_mask:0xf bank_mask:0xc
  v_add_f32_dpp v58, v58, v58 row_ror:4 row_mask:0xf bank_mask:0xf
  v_add_f32_dpp v59, v59, v59 row_ror:4 row_mask:0xf bank_mask:0xf
  v_mov_b32_dpp v62, v52 row_newbcast:0 row_mask:0xf bank_mask:0x3
  v_mov_b32_dpp v62, v52 row_newbcast:1 row_mask:0xf bank_mask:0xc
  v_add_f32_dpp v58, v58, v58 row_ror:2 row_mask:0xf bank_mask:0xf
  v_add_f32_dpp v59, v59, v59 row_ror:2 row_mask:0xf bank_mask:0xf
  v_mov_b32_dpp v63, v52 row_newbcast:8 row_mask:0xf bank_mask:0x3
  v_mov_b32_dpp v63, v52 row_newbcast:9 row_mask:0xf bank_mask:0xc
  v_add_f32_dpp v58, v58, v58 row_ror:1 row_mask:0xf bank_mask:0xf
  v_add_f32_dpp v59, v59, v59 row_ror:1 row_mask:0xf bank_mask:0xf
  v_mul_f32 v32, v60, v32
  v_mul_f32 v33, v60, v33
  v_mul_f32 v34, v60, v34
  v_mul_f32 v35, v60, v35
  v_mul_f32 v40, v62, v40
  v_mul_f32 v41, v62, v41
  v_mul_f32 v42, v62, v42
  v_mul_f32 v43, v62, v43
  v_rcp_f32 v58, v58
  v_rcp_f32 v59, v59
  v_fmac_f32 v32, v61, v36
  v_fmac_f32 v33, v61, v37
  v_fmac_f32 v34, v61, v38
  v_fmac_f32 v35, v61, v39
  v_fmac_f32 v40, v63, v44
  v_fmac_f32 v41, v63, v45
  v_fmac_f32 v42, v63, v46
  v_fmac_f32 v43, v63, v47
  v_cndmask_b32 v36, v34, v32, s[84:85]
  v_cndmask_b32 v37, v35, v33, s[84:85]
  v_cndmask_b32 v38, v32, v34, s[84:85]
  v_cndmask_b32 v39, v33, v35, s[84:85]
  v_cndmask_b32 v44, v42, v40, s[84:85]
  v_cndmask_b32 v45, v43, v41, s[84:85]
  v_cndmask_b32 v46, v40, v42, s[84:85]
  v_cndmask_b32 v47, v41, v43, s[84:85]
  v_add_f32_dpp v38, v36, v38 row_ror:8 row_mask:0xf bank_mask:0xf
  v_add_f32_dpp v39, v37, v39 row_ror:8 row_mask:0xf bank_mask:0xf
  v_add_f32_dpp v46, v44, v46 row_ror:8 row_mask:0xf bank_mask:0xf
  v_add_f32_dpp v47, v45, v47 row_ror:8 row_mask:0xf bank_mask:0xf
  v_mov_b32 v32, v38
  v_mov_b32 v33, v39
  v_mov_b32 v40, v46
  v_mov_b32 v41, v47
  v_permlane16_swap_b32 v38, v32
  v_permlane16_swap_b32 v39, v33
  v_permlane16_swap_b32 v46, v40
  v_permlane16_swap_b32 v47, v41
  v_add_f32 v38, v38, v32
  v_add_f32 v39, v39, v33
  v_add_f32 v46, v46, v40
  v_add_f32 v47, v47, v41
  v_mov_b32 v32, v38
  v_mov_b32 v33, v39
  v_mov_b32 v40, v46
  v_mov_b32 v41, v47
  v_permlane32_swap_b32 v38, v32
  v_permlane32_swap_b32 v39, v33
  v_permlane32_swap_b32 v46, v40
  v_permlane32_swap_b32 v47, v41
  v_add_f32 v38, v38, v32
  v_add_f32 v39, v39, v33
  v_add_f32 v46, v46, v40
  v_add_f32 v47, v47, v41
  v_mul_f32 v38, v58, v38
  v_mul_f32 v39, v58, v39
  v_mul_f32 v46, v59, v46
  v_mul_f32 v47, v59, v47
  v_cvt_pk_bf16_f32 v60, v38, v39
  v_cvt_pk_bf16_f32 v61, v46, v47
  s_mov_b64 exec, 0xffff
  ds_write_b32 v12, v60 offset:2560
  ds_write_b32 v12, v61 offset:2624
  s_mov_b64 exec, -1
  s_mov_b32 s48, s24
  s_mov_b32 s49, s25
  s_mov_b32 s50, 4096
  s_mov_b32 s51, 0x20000
  s_waitcnt lgkmcnt(0)
  s_barrier
  s_bitcmp1_b32 s11, 0
  s_cbranch_scc1 L_GEND
  s_sleep 34
  s_mov_b32 s22, 0x00003f80
  s_mov_b32 s23, 0x3f800000
  s_mov_b64 s[32:33], exec
  s_mov_b64 s[34:35], exec
  s_mov_b64 s[36:37], exec
  s_mov_b64 s[38:39], exec
  s_mov_b64 s[40:41], exec
  s_mov_b64 s[42:43], exec
  s_mov_b64 s[44:45], exec
  s_mov_b64 s[46:47], exec
  s_mov_b32 s57, 200000
L_H2:
  s_mov_b64 exec, s[32:33]
  s_cbranch_execz L_H2_k0
  buffer_load_dwordx4 v[64:67], v10, s[52:55], s13 offen offset:0 sc1
L_H2_k0:
  s_mov_b64 exec, s[34:35]
  s_cbranch_execz L_H2_k1
  buffer_load_dwordx4 v[68:71], v10, s[52:55], s13 offen offset:1024 sc1
L_H2_k1:
  s_mov_b64 exec, s[36:37]
  s_cbranch_execz L_H2_k2
  buffer_load_dwordx4 v[72:75], v10, s[52:55], s13 offen offset:2048 sc1
L_H2_k2:
  s_mov_b64 exec, s[38:39]
  s_cbranch_execz L_H2_k3
  buffer_load_dwordx4 v[76:79], v10, s[52:55], s13 offen offset:3072 sc1
L_H2_k3:
  s_mov_b64 exec, s[40:41]
  s_cbranch_execz L_H2_k4
  buffer_load_dwordx4 v[80:83], v10, s[52:55], s18 offen offset:0 sc1
L_H2_k4:
  s_mov_b64 exec, s[42:43]
  s_cbranch_execz L_H2_k5
  buffer_load_dwordx4 v[84:87], v10, s[52:55], s18 offen offset:1024 sc1
L_H2_k5:
  s_mov_b64 exec, s[44:45]
  s_cbranch_execz L_H2_k6
  buffer_load_dwordx4 v[88:91], v10, s[52:55], s18 offen offset:2048 sc1
L_H2_k6:
  s_mov_b64 exec, s[46:47]
  s_cbranch_execz L_H2_k7
  buffer_load_dwordx4 v[92:95], v10, s[52:55], s18 offen offset:3072 sc1
L_H2_k7:
  s_waitcnt vmcnt(0)
  s_mov_b64 exec, s[32:33]
  v_cmp_ne_u64 s[32:33], v[66:67], s[76:77]
  s_mov_b64 exec, s[34:35]
  v_cmp_ne_u64 s[34:35], v[70:71], s[76:77]
  s_mov_b64 exec, s[36:37]
  v_cmp_ne_u64 s[36:37], v[74:75], s[76:77]
  s_mov_b64 exec, s[38:39]
  v_cmp_ne_u64 s[38:39], v[78:79], s[76:77]
  s_mov_b64 exec, s[40:41]
  v_cmp_ne_u64 s[40:41], v[82:83], s[76:77]
  s_mov_b64 exec, s[42:43]
  v_cmp_ne_u64 s[42:43], v[86:87], s[76:77]
  s_mov_b64 exec, s[44:45]
  v_cmp_ne_u64 s[44:45], v[90:91], s[76:77]
  s_mov_b64 exec, s[46:47]
  v_cmp_ne_u64 s[46:47], v[94:95], s[76:77]
  s_mov_b64 exec, -1
  s_or_b64 s[58:59], s[32:33], s[34:35]
  s_or_b64 s[58:59], s[58:59], s[36:37]
  s_or_b64 s[58:59], s[58:59], s[38:39]
  s_or_b64 s[58:59], s[58:59], s[40:41]
  s_or_b64 s[58:59], s[58:59], s[42:43]
  s_or_b64 s[58:59], s[58:59], s[44:45]
  s_or_b64 s[58:59], s[58:59], s[46:47]
  s_cmp_eq_u64 s[58:59], 0
  s_cbranch_scc1 L_H2D
  s_bcnt1_i32_b64 s56, s[58:59]
  s_cmp_gt_u32 s56, 24
  s_cbranch_scc0 L_H2_s
  s_sleep 8
L_H2_s:
  s_sub_u32 s57, s57, 1
  s_cmp_eq_u32 s57, 0
  s_cbranch_scc0 L_H2
L_H2D:
  v_dot2_f32_bf16 v100, v64, s22, 0
  v_dot2_f32_bf16 v101, v64, s23, 0
  v_dot2_f32_bf16 v102, v65, s22, 0
  v_dot2_f32_bf16 v103, v65, s23, 0
  v_dot2_f32_bf16 v104, v68, s22, 0
  v_dot2_f32_bf16 v105, v68, s23, 0
  v_dot2_f32_bf16 v106, v69, s22, 0
  v_dot2_f32_bf16 v107, v69, s23, 0
  v_dot2_f32_bf16 v100, v72, s22, v100
  v_dot2_f32_bf16 v101, v72, s23, v101
  v_dot2_f32_bf16 v102, v73, s22, v102
  v_dot2_f32_bf16 v103, v73, s23, v103
  v_dot2_f32_bf16 v104, v76, s22, v104
  v_dot2_f32_bf16 v105, v76, s23, v105
  v_dot2_f32_bf16 v106, v77, s22, v106
  v_dot2_f32_bf16 v107, v77, s23, v107
  v_dot2_f32_bf16 v100, v80, s22, v100
  v_dot2_f32_bf16 v101, v80, s23, v101
  v_dot2_f32_bf16 v102, v81, s22, v102
  v_dot2_f32_bf16 v103, v81, s23, v103
  v_dot2_f32_bf16 v104, v84, s22, v104
  v_dot2_f32_bf16 v105, v84, s23, v105
  v_dot2_f32_bf16 v106, v85, s22, v106
  v_dot2_f32_bf16 v107, v85, s23, v107
  v_dot2_f32_bf16 v100, v88, s22, v100
  v_dot2_f32_bf16 v101, v88, s23, v101
  v_dot2_f32_bf16 v102, v89, s22, v102
  v_dot2_f32_bf16 v103, v89, s23, v103
  v_dot2_f32_bf16 v104, v92, s22, v104
  v_dot2_f32_bf16 v105, v92, s23, v105
  v_dot2_f32_bf16 v106, v93, s22, v106
  v_dot2_f32_bf16 v107, v93, s23, v107
  s_nop 3
  v_add_f32 v100, v100, v104
  v_add_f32 v101, v101, v105
  v_add_f32 v102, v102, v106
  v_add_f32 v103, v103, v107
  v_add_f32_dpp v100, v100, v100 row_ror:4 row_mask:0xf bank_mask:0xf
  v_add_f32_dpp v101, v101, v101 row_ror:4 row_mask:0xf bank_mask:0xf
  v_add_f32_dpp v102, v102, v102 row_ror:4 row_mask:0xf bank_mask:0xf
  v_add_f32_dpp v103, v103, v103 row_ror:4 row_mask:0xf bank_mask:0xf
  v_add_f32_dpp v100, v100, v100 row_ror:8 row_mask:0xf bank_mask:0xf
  v_add_f32_dpp v101, v101, v101 row_ror:8 row_mask:0xf bank_mask:0xf
  v_add_f32_dpp v102, v102, v102 row_ror:8 row_mask:0xf bank_mask:0xf
  v_add_f32_dpp v103, v103, v103 row_ror:8 row_mask:0xf bank_mask:0xf
  v_mov_b32 v104, v100
  v_mov_b32 v105, v101
  v_mov_b32 v106, v102
  v_mov_b32 v107, v103
  v_permlane16_swap_b32 v100, v104
  v_permlane16_swap_b32 v101, v105
  v_permlane16_swap_b32 v102, v106
  v_permlane16_swap_b32 v103, v107
  v_add_f32 v100, v100, v104
  v_add_f32 v101, v101, v105
  v_add_f32 v102, v102, v106
  v_add_f32 v103, v103, v107
  v_mov_b32 v104, v100
  v_mov_b32 v105, v101
  v_mov_b32 v106, v102
  v_mov_b32 v107, v103
  v_permlane32_swap_b32 v100, v104
  v_permlane32_swap_b32 v101, v105
  v_permlane32_swap_b32 v102, v106
  v_permlane32_swap_b32 v103, v107
  v_add_f32 v100, v100, v104
  v_add_f32 v101, v101, v105
  v_add_f32 v102, v102, v106
  v_add_f32 v103, v103, v107
  v_cvt_pk_bf16_f32 v108, v100, v101
  v_cvt_pk_bf16_f32 v109, v102, v103
  s_mov_b64 exec, 15
  buffer_store_dwordx2 v[108:109], v13, s[48:51], s14 offen
L_GEND:
L_END:
  s_endpgm
.section .rodata,"a"
.p2align 6
.amdhsa_kernel concat_heads__sliding_block_cached__gqa_block_cached__decode_kernel
  .amdhsa_next_free_vgpr 256
  .amdhsa_next_free_sgpr 102
  .amdhsa_accum_offset 256
  .amdhsa_group_segment_fixed_size 0
  .amdhsa_kernarg_size 104
  .amdhsa_user_sgpr_count 2
  .amdhsa_user_sgpr_kernarg_segment_ptr 1
  .amdhsa_system_sgpr_workgroup_id_x 1
.end_amdhsa_kernel
```
